```python
import torch

def _softmax(x, axis=-1):
    return torch.softmax(x, dim=axis)
def _gelu(x):
    return torch.nn.functional.gelu(x, approximate="tanh")
def _silu(x):
    return torch.nn.functional.silu(x)
def _sigmoid(x):
    return torch.sigmoid(x)
def _layernorm(x, axis=-1, eps=1e-5):
    m = x.mean(dim=axis, keepdim=True)
    v = x.var(dim=axis, keepdim=True, unbiased=False)
    return (x - m) / torch.sqrt(v + eps)
def _scatter_add(tgt, idx, src, axis=0):
    return tgt.clone().index_add_(axis, idx, src)
def _segment_sum(src, seg, n):
    out = torch.zeros((n,) + src.shape[1:], dtype=src.dtype)
    return out.index_add_(0, seg, src)
def _pad(x, pw):
    flat = tuple(v for pair in reversed(pw) for v in pair)
    return torch.nn.functional.pad(x, flat)

kernel_name = 'parallel_sum__mha_block_cached__dense_activation_silu__decode'

def setup_inputs():

    _w = (lambda a: (lambda t: t.to(torch.bfloat16) if t.is_floating_point() else t)(torch.as_tensor(a)))
    def _A_setup():
        B, Sq, D = 2, 1, 640
        H, Sk, Dh = 32, 4096, 128
        return {
            "x": _w((lambda *s: torch.randn(*s, dtype=torch.bfloat16) * 0.05)(B, Sq, D)),
            "k_cache": _w((lambda *s: torch.randn(*s, dtype=torch.bfloat16) * 3.2)(B, H, Sk, Dh)),
            "v_cache": _w((lambda *s: torch.randn(*s, dtype=torch.bfloat16) * 0.8)(B, H, Sk, Dh)),
            "wq": _w((lambda *s: torch.randn(*s, dtype=torch.bfloat16) * 3.2)(D, H * Dh) * (D ** -0.5)),
            "wo": _w((lambda *s: torch.randn(*s, dtype=torch.bfloat16) * 0.8)(H * Dh, D) * ((H * Dh) ** -0.5)),
        }
    _A_in = _A_setup()

    def _B_setup():
        B, S, D, F = 2, 1, 640, 1728
        return {
            "x": _w((lambda *s: torch.randn(*s, dtype=torch.bfloat16) * 0.05)(B, S, D)),
            "w1": _w((lambda *s: torch.randn(*s, dtype=torch.bfloat16) * 3.2)(D, F) * (D ** -0.5)),
            "w2": _w((lambda *s: torch.randn(*s, dtype=torch.bfloat16) * 0.4)(F, D) * (F ** -0.5)),
        }
    _B_in = _B_setup()

    return {
        "A_x": _A_in["x"],
        "A_k_cache": _A_in["k_cache"],
        "A_v_cache": _A_in["v_cache"],
        "A_wq": _A_in["wq"],
        "A_wo": _A_in["wo"],
        "B_x": _B_in["x"],
        "B_w1": _B_in["w1"],
        "B_w2": _B_in["w2"],
    }

def reference(A_x, A_k_cache, A_v_cache, A_wq, A_wo, B_x, B_w1, B_w2):
    def _A_ref(x, k_cache, v_cache, wq, wo):
        B, Sq, D = x.shape
        H, Dh = 32, 128
        q = (lambda x, *d: x.permute(*d))((x @ wq).reshape(B, Sq, H, Dh), 0, 2, 1, 3)
        scores = torch.einsum("bhqd,bhkd->bhqk", q, k_cache) * (Dh ** -0.5)
        p = _softmax(scores, axis=-1)
        o = torch.einsum("bhqk,bhkd->bhqd", p, v_cache)
        return (lambda x, *d: x.permute(*d))(o, 0, 2, 1, 3).reshape(B, Sq, H * Dh) @ wo

    def _B_ref(x, w1, w2):
        h = torch.einsum("bsd,df->bsf", x, w1)
        h = _silu(h)
        out = torch.einsum("bsf,fd->bsd", h, w2)
        return out

    x = A_x
    xn = _layernorm(x, axis=-1)
    return x + _A_ref(xn, A_k_cache, A_v_cache, A_wq, A_wo) + _B_ref(xn, B_w1, B_w2)
```

```asm
    ; @launch grid=(256,1,1) block=(512,1,1) lds=45056
    .amdgcn_target "amdgcn-amd-amdhsa--gfx950"
    .text
    .globl parallel_sum__mha_block_cached__dense_activation_silu__decode_kernel
    .p2align 8
    .type parallel_sum__mha_block_cached__dense_activation_silu__decode_kernel,@function
parallel_sum__mha_block_cached__dense_activation_silu__decode_kernel:
    s_cmp_ge_u32 s2, 256
    s_cbranch_scc1 L_end
    s_load_dwordx16 s[16:31], s[0:1], 0
    s_load_dwordx2 s[32:33], s[0:1], 64
    s_load_dwordx2 s[36:37], s[0:1], 80
    v_lshrrev_b32 v1, 6, v0
    v_and_b32 v0, 63, v0
    v_readfirstlane_b32 s3, v1
    v_mov_b32 v2, 0
    v_mov_b32 v4, 0
    v_mov_b32 v5, 0
    v_mov_b32 v6, 0
    v_mov_b32 v7, 0
    s_and_b32 s4, s2, 7
    s_lshl_b32 s4, s4, 2
    s_lshr_b32 s60, s2, 6
    s_add_u32 s4, s4, s60
    s_lshr_b32 s5, s2, 3
    s_and_b32 s5, s5, 7
    s_lshr_b32 s6, s5, 2
    s_lshl_b32 s7, s4, 3
    s_add_u32 s7, s7, s5
    s_cmp_lg_u32 s3, 0
    s_cbranch_scc1 L_noinit
    ds_write_b128 v2, v[4:7]
    ds_write_b128 v2, v[4:7] offset:16
    s_waitcnt lgkmcnt(0)
L_noinit:
    s_barrier
    s_cmp_ge_u32 s3, 4
    s_cbranch_scc1 L_stream
    s_setprio 3
    v_lshrrev_b32 v2, 4, v0
    v_and_b32 v3, 15, v0
    s_mul_i32 s64, s5, 80
    s_mul_i32 s60, s3, 20
    s_add_u32 s64, s64, s60
    s_lshl_b32 s96, s64, 13
    s_lshl_b32 s60, s4, 8
    s_add_u32 s96, s96, s60
    s_mul_i32 s97, s64, 3456
    s_lshl_b32 s60, s4, 7
    s_add_u32 s97, s97, s60
    s_lshl_b32 s67, s64, 1
    s_lshl_b32 s61, s7, 10
    s_mov_b32 s78, 0xffffffc0
    s_getreg_b32 s39, hwreg(HW_REG_XCC_ID, 0, 3)
    v_lshlrev_b32 v27, 4, v3
    v_lshlrev_b32 v26, 13, v2
    v_add_u32 v93, v26, v27
    v_mul_u32_u24 v26, 3456, v2
    v_add_u32 v94, v26, v27
    v_mov_b32 v26, 0x80000000
    v_cmp_gt_u32 vcc, 8, v3
    s_nop 1
    v_cndmask_b32 v94, v26, v94, vcc
    v_lshrrev_b32 v26, 5, v0
    v_mul_u32_u24 v26, 1280, v26
    v_and_b32 v27, 31, v0
    v_lshl_add_u32 v90, v27, 4, v26
    v_lshl_add_u32 v91, v27, 3, v26
    v_lshlrev_b32 v27, 2, v3
    v_add_u32 v27, v27, v2
    v_lshlrev_b32 v92, 1, v27
    s_cmp_lt_u32 s4, 27
    s_cselect_b32 s65, 0x21c000, 0
    s_waitcnt lgkmcnt(0)
    s_mov_b32 s40, s16
    s_and_b32 s41, s17, 0xffff
    s_mov_b32 s42, 0xa00
    s_mov_b32 s43, 0x20000
    s_mov_b32 s8, s22
    s_and_b32 s9, s23, 0xffff
    s_mov_b32 s10, 0x500000
    s_mov_b32 s11, 0x20000
    buffer_load_dwordx4 v[60:63], v90, s[40:43], 0 offen
    buffer_load_dwordx4 v[64:67], v90, s[40:43], 0 offen offset:512
    buffer_load_dwordx2 v[68:69], v91, s[40:43], 0 offen offset:1024
    buffer_load_ushort v22, v92, s[40:43], s67 offen
    buffer_load_ushort v23, v92, s[40:43], s67 offen offset:1280
    buffer_load_dwordx4 v[96:99], v93, s[8:11], s96 offen nt
    s_add_u32 s96, s96, 32768
    buffer_load_dwordx4 v[100:103], v93, s[8:11], s96 offen nt
    s_add_u32 s96, s96, 32768
    buffer_load_dwordx4 v[104:107], v93, s[8:11], s96 offen nt
    s_add_u32 s96, s96, 32768
    s_mov_b32 s12, s28
    s_and_b32 s13, s29, 0xffff
    s_mov_b32 s14, 0x0
    s_mov_b32 s15, 0x20000
    s_mov_b32 s14, s65
    s_mov_b32 s56, s30
    s_and_b32 s57, s31, 0xffff
    s_mov_b32 s58, 0x21c000
    s_mov_b32 s59, 0x20000
    s_lshl_b32 s98, s4, 6
    s_lshl_b32 s60, s3, 4
    s_add_u32 s98, s98, s60
    s_mul_i32 s98, s98, 1280
    s_mul_i32 s60, s5, 160
    s_add_u32 s98, s98, s60
    s_lshl_b32 s99, s4, 7
    s_lshl_b32 s62, s3, 5
    s_add_u32 s99, s99, s62
    s_mul_i32 s99, s99, 1280
    s_add_u32 s99, s99, s60
    s_mov_b32 s44, s36
    s_and_b32 s45, s37, 0xffff
    s_mov_b32 s46, 0x260000
    s_mov_b32 s47, 0x20000
    s_mov_b32 s60, 0x140000
    s_load_dword s38, s[36:37], s60
    v_and_b32 v29, 7, v3
    v_and_b32 v26, 1, v29
    v_lshlrev_b32 v26, 4, v26
    v_mov_b32 v27, 0xffff
    v_lshlrev_b32 v26, v26, v27
    v_lshrrev_b32 v28, 1, v29
    v_cmp_eq_u32 vcc, 0, v28
    s_nop 1
    v_cndmask_b32 v4, 0, v26, vcc
    v_cmp_eq_u32 vcc, 1, v28
    s_nop 1
    v_cndmask_b32 v5, 0, v26, vcc
    v_cmp_eq_u32 vcc, 2, v28
    s_nop 1
    v_cndmask_b32 v6, 0, v26, vcc
    v_cmp_eq_u32 vcc, 3, v28
    s_nop 1
    v_cndmask_b32 v7, 0, v26, vcc
    v_lshrrev_b32 v26, 3, v3
    v_lshlrev_b32 v26, 5, v26
    v_lshlrev_b32 v27, 3, v2
    v_add3_u32 v26, v26, v27, v29
    v_lshlrev_b32 v34, 4, v26
    v_mul_u32_u24 v26, 1280, v2
    v_lshlrev_b32 v27, 4, v3
    v_add_u32 v35, v26, v27
    v_mov_b32 v26, 0x80000000
    v_cmp_gt_u32 vcc, 10, v3
    s_nop 1
    v_cndmask_b32 v35, v26, v35, vcc
    v_lshlrev_b32 v24, 4, v0
    s_lshl_b32 s60, s3, 10
    v_add_u32 v25, s60, v24
    s_waitcnt vmcnt(5)
    v_lshlrev_b32 v70, 16, v60
    v_and_b32 v71, 0xffff0000, v60
    v_lshlrev_b32 v72, 16, v61
    v_and_b32 v73, 0xffff0000, v61
    v_lshlrev_b32 v74, 16, v62
    v_and_b32 v75, 0xffff0000, v62
    v_lshlrev_b32 v76, 16, v63
    v_and_b32 v77, 0xffff0000, v63
    v_lshlrev_b32 v78, 16, v64
    v_and_b32 v79, 0xffff0000, v64
    v_lshlrev_b32 v80, 16, v65
    v_and_b32 v81, 0xffff0000, v65
    v_lshlrev_b32 v82, 16, v66
    v_and_b32 v83, 0xffff0000, v66
    v_lshlrev_b32 v84, 16, v67
    v_and_b32 v85, 0xffff0000, v67
    v_lshlrev_b32 v86, 16, v68
    v_and_b32 v87, 0xffff0000, v68
    v_lshlrev_b32 v88, 16, v69
    v_and_b32 v89, 0xffff0000, v69
    v_add_f32 v26, v70, v71
    v_add_f32 v27, v72, v73
    v_add_f32 v26, v26, v74
    v_add_f32 v27, v27, v75
    v_add_f32 v26, v26, v76
    v_add_f32 v27, v27, v77
    v_add_f32 v26, v26, v78
    v_add_f32 v27, v27, v79
    v_add_f32 v26, v26, v80
    v_add_f32 v27, v27, v81
    v_add_f32 v26, v26, v82
    v_add_f32 v27, v27, v83
    v_add_f32 v26, v26, v84
    v_add_f32 v27, v27, v85
    v_add_f32 v26, v26, v86
    v_add_f32 v27, v27, v87
    v_add_f32 v26, v26, v88
    v_add_f32 v27, v27, v89
    v_add_f32 v26, v26, v27
    s_nop 1
    v_add_f32_dpp v26, v26, v26 row_ror:8 row_mask:0xf bank_mask:0xf
    s_nop 1
    v_add_f32_dpp v26, v26, v26 row_ror:4 row_mask:0xf bank_mask:0xf
    s_nop 1
    v_add_f32_dpp v26, v26, v26 row_ror:2 row_mask:0xf bank_mask:0xf
    s_nop 1
    v_add_f32_dpp v26, v26, v26 row_ror:1 row_mask:0xf bank_mask:0xf
    v_mov_b32 v27, v26
    s_nop 1
    v_permlane16_swap_b32 v26, v27
    v_add_f32 v26, v26, v27
    v_mul_f32 v26, 0x3acccccd, v26
    v_mov_b32 v28, 0
    v_mov_b32 v29, 0
    v_sub_f32 v30, v70, v26
    v_sub_f32 v31, v71, v26
    v_fmac_f32 v28, v30, v30
    v_fmac_f32 v29, v31, v31
    v_sub_f32 v30, v72, v26
    v_sub_f32 v31, v73, v26
    v_fmac_f32 v28, v30, v30
    v_fmac_f32 v29, v31, v31
    v_sub_f32 v30, v74, v26
    v_sub_f32 v31, v75, v26
    v_fmac_f32 v28, v30, v30
    v_fmac_f32 v29, v31, v31
    v_sub_f32 v30, v76, v26
    v_sub_f32 v31, v77, v26
    v_fmac_f32 v28, v30, v30
    v_fmac_f32 v29, v31, v31
    v_sub_f32 v30, v78, v26
    v_sub_f32 v31, v79, v26
    v_fmac_f32 v28, v30, v30
    v_fmac_f32 v29, v31, v31
    v_sub_f32 v30, v80, v26
    v_sub_f32 v31, v81, v26
    v_fmac_f32 v28, v30, v30
    v_fmac_f32 v29, v31, v31
    v_sub_f32 v30, v82, v26
    v_sub_f32 v31, v83, v26
    v_fmac_f32 v28, v30, v30
    v_fmac_f32 v29, v31, v31
    v_sub_f32 v30, v84, v26
    v_sub_f32 v31, v85, v26
    v_fmac_f32 v28, v30, v30
    v_fmac_f32 v29, v31, v31
    v_sub_f32 v30, v86, v26
    v_sub_f32 v31, v87, v26
    v_fmac_f32 v28, v30, v30
    v_fmac_f32 v29, v31, v31
    v_sub_f32 v30, v88, v26
    v_sub_f32 v31, v89, v26
    v_fmac_f32 v28, v30, v30
    v_fmac_f32 v29, v31, v31
    v_add_f32 v28, v28, v29
    s_nop 1
    v_add_f32_dpp v28, v28, v28 row_ror:8 row_mask:0xf bank_mask:0xf
    s_nop 1
    v_add_f32_dpp v28, v28, v28 row_ror:4 row_mask:0xf bank_mask:0xf
    s_nop 1
    v_add_f32_dpp v28, v28, v28 row_ror:2 row_mask:0xf bank_mask:0xf
    s_nop 1
    v_add_f32_dpp v28, v28, v28 row_ror:1 row_mask:0xf bank_mask:0xf
    v_mov_b32 v27, v28
    s_nop 1
    v_permlane16_swap_b32 v28, v27
    v_add_f32 v28, v28, v27
    v_mul_f32 v28, 0x3acccccd, v28
    v_cvt_pk_bf16_f32 v27, v26, v26
    v_and_b32 v26, 0xffff0000, v27
    v_cvt_pk_bf16_f32 v27, v28, v28
    v_and_b32 v28, 0xffff0000, v27
    v_add_f32 v28, 0x3727c5ac, v28
    v_cvt_pk_bf16_f32 v27, v28, v28
    v_and_b32 v28, 0xffff0000, v27
    v_sqrt_f32 v28, v28
    s_nop 0
    v_cvt_pk_bf16_f32 v27, v28, v28
    v_and_b32 v28, 0xffff0000, v27
    v_rcp_f32 v29, v28
    v_readlane_b32 s64, v26, 0
    v_readlane_b32 s65, v28, 0
    v_readlane_b32 s66, v29, 0
    v_readlane_b32 s67, v26, 32
    v_readlane_b32 s68, v28, 32
    v_readlane_b32 s69, v29, 32
    s_waitcnt vmcnt(3)
    v_lshlrev_b32 v22, 16, v22
    v_subrev_f32 v22, s64, v22
    v_cvt_pk_bf16_f32 v30, v22, v22
    v_and_b32 v22, 0xffff0000, v30
    v_mul_f32 v31, s66, v22
    v_fma_f32 v32, -v31, s65, v22
    v_fma_f32 v31, v32, s66, v31
    v_cvt_pk_bf16_f32 v22, v31, v31
    v_lshlrev_b32 v23, 16, v23
    v_subrev_f32 v23, s67, v23
    v_cvt_pk_bf16_f32 v30, v23, v23
    v_and_b32 v23, 0xffff0000, v30
    v_mul_f32 v31, s69, v23
    v_fma_f32 v32, -v31, s68, v23
    v_fma_f32 v31, v32, s69, v31
    v_cvt_pk_bf16_f32 v23, v31, v31
    v_mov_b32_dpp v8, v22 row_newbcast:0 row_mask:0xf bank_mask:0x3
    s_nop 1
    v_mov_b32_dpp v8, v23 row_newbcast:0 row_mask:0xf bank_mask:0xc
    v_and_b32 v136, v8, v4
    v_and_b32 v137, v8, v5
    v_and_b32 v138, v8, v6
    v_and_b32 v139, v8, v7
    v_mov_b32_dpp v9, v22 row_newbcast:1 row_mask:0xf bank_mask:0x3
    s_nop 1
    v_mov_b32_dpp v9, v23 row_newbcast:1 row_mask:0xf bank_mask:0xc
    v_and_b32 v140, v9, v4
    v_and_b32 v141, v9, v5
    v_and_b32 v142, v9, v6
    v_and_b32 v143, v9, v7
    v_mov_b32_dpp v8, v22 row_newbcast:2 row_mask:0xf bank_mask:0x3
    s_nop 1
    v_mov_b32_dpp v8, v23 row_newbcast:2 row_mask:0xf bank_mask:0xc
    v_and_b32 v144, v8, v4
    v_and_b32 v145, v8, v5
    v_and_b32 v146, v8, v6
    v_and_b32 v147, v8, v7
    v_mov_b32_dpp v9, v22 row_newbcast:3 row_mask:0xf bank_mask:0x3
    s_nop 1
    v_mov_b32_dpp v9, v23 row_newbcast:3 row_mask:0xf bank_mask:0xc
    v_and_b32 v148, v9, v4
    v_and_b32 v149, v9, v5
    v_and_b32 v150, v9, v6
    v_and_b32 v151, v9, v7
    v_mov_b32_dpp v8, v22 row_newbcast:4 row_mask:0xf bank_mask:0x3
    s_nop 1
    v_mov_b32_dpp v8, v23 row_newbcast:4 row_mask:0xf bank_mask:0xc
    v_and_b32 v152, v8, v4
    v_and_b32 v153, v8, v5
    v_and_b32 v154, v8, v6
    v_and_b32 v155, v8, v7
    s_waitcnt vmcnt(2)
    buffer_load_dwordx4 v[108:111], v93, s[8:11], s96 offen nt
    s_add_u32 s96, s96, 32768
    v_mfma_f32_16x16x32_bf16 v[18:21], v[96:99], v[136:139], 0
    s_waitcnt vmcnt(2)
    buffer_load_dwordx4 v[112:115], v93, s[8:11], s96 offen nt
    v_mfma_f32_16x16x32_bf16 v[18:21], v[100:103], v[140:143], v[18:21]
    s_waitcnt vmcnt(2)
    buffer_load_dwordx4 v[116:119], v94, s[12:15], s97 offen nt
    s_add_u32 s97, s97, 13824
    v_mfma_f32_16x16x32_bf16 v[18:21], v[104:107], v[144:147], v[18:21]
    s_waitcnt vmcnt(2)
    buffer_load_dwordx4 v[120:123], v94, s[12:15], s97 offen nt
    s_add_u32 s97, s97, 13824
    v_mfma_f32_16x16x32_bf16 v[18:21], v[108:111], v[148:151], v[18:21]
    s_waitcnt vmcnt(2)
    buffer_load_dwordx4 v[124:127], v94, s[12:15], s97 offen nt
    s_add_u32 s97, s97, 13824
    v_mfma_f32_16x16x32_bf16 v[18:21], v[112:115], v[152:155], v[18:21]
    s_nop 7
    ds_write_b128 v25, v[18:21] offset:4096
    s_waitcnt lgkmcnt(0)
    s_mov_b64 exec, 1
    v_mov_b32 v26, 0
    v_mov_b32 v27, 1
    ds_add_u32 v26, v27 offset:0
    s_mov_b64 exec, -1
    s_waitcnt lgkmcnt(0)
    s_add_u32 s38, s38, 8
    v_mov_b32 v59, s38
    v_and_b32 v53, 0x38, v59
    v_lshrrev_b32 v26, 3, v0
    v_lshlrev_b32 v26, 10, v26
    v_and_b32 v27, 7, v0
    v_lshl_add_u32 v95, v27, 4, v26
    s_lshl_b32 s70, s4, 13
    s_lshl_b32 s60, s6, 9
    s_add_u32 s62, s70, s60
    s_lshl_b32 s60, s3, 7
    s_add_u32 s62, s62, s60
    s_mov_b32 s73, -1
    v_mov_b32 v26, 0
    s_mov_b32 s79, 800000
L_wq4:
    ds_read_b32 v27, v26 offset:0
    s_waitcnt lgkmcnt(0)
    v_cmp_ne_u32 vcc, 4, v27
    s_cbranch_vccz L_wq4_done
    s_sub_u32 s79, s79, 1
    s_cbranch_scc0 L_wq4
L_wq4_done:
    s_cmp_lg_u32 s3, 0
    s_cbranch_scc1 L_pubq_done
    ds_read_b128 v[36:39], v24 offset:4096
    ds_read_b128 v[40:43], v24 offset:5120
    ds_read_b128 v[44:47], v24 offset:6144
    ds_read_b128 v[48:51], v24 offset:7168
    s_waitcnt lgkmcnt(0)
    v_add_f32 v36, v36, v40
    v_add_f32 v44, v44, v48
    v_add_f32 v37, v37, v41
    v_add_f32 v45, v45, v49
    v_add_f32 v38, v38, v42
    v_add_f32 v46, v46, v50
    v_add_f32 v39, v39, v43
    v_add_f32 v47, v47, v51
    v_add_f32 v160, v36, v44
    v_add_f32 v161, v37, v45
    v_add_f32 v162, v38, v46
    v_add_f32 v163, v39, v47
    v_or_b32 v30, s39, v53
    v_add_u32 v160, 0x20, v160
    v_add_u32 v161, 0x20, v161
    v_add_u32 v162, 0x20, v162
    v_add_u32 v163, 0x20, v163
    v_and_or_b32 v160, v160, s78, v30
    v_and_or_b32 v161, v161, s78, v30
    v_and_or_b32 v162, v162, s78, v30
    v_and_or_b32 v163, v163, s78, v30
    s_add_u32 s71, s61, 0x0
    buffer_store_dwordx4 v[160:163], v34, s[44:47], s71 offen
    s_mov_b32 s73, 5
L_pubq_done:
    s_mov_b32 s79, 40000
L_pollq:
    buffer_load_dwordx4 v[36:39], v95, s[44:47], s62 offen sc1
    s_waitcnt vmcnt(0)
    v_xor_b32 v27, v36, v37
    v_xor_b32 v28, v36, v38
    v_xor_b32 v29, v36, v39
    v_or3_b32 v26, v27, v28, v29
    v_and_b32 v26, 0x3f, v26
    v_xor_b32 v27, v36, v53
    v_and_or_b32 v26, v27, 56, v26
    v_cmp_ne_u32 vcc, 0, v26
    s_cbranch_vccz L_pollq_done
    s_sub_u32 s73, s73, 1
    s_cmp_lg_u32 s73, 0
    s_cbranch_scc1 L_pollq_next
    buffer_store_dwordx4 v[160:163], v34, s[44:47], s71 offen sc1
L_pollq_next:
    s_sub_u32 s79, s79, 1
    s_cbranch_scc0 L_pollq
L_pollq_done:
    v_and_b32 v26, 7, v36
    v_cmp_ne_u32 vcc, s39, v26
    s_nop 0
    s_cmp_lg_u64 vcc, 0
    s_cselect_b32 s72, 1, 0
    s_cbranch_scc0 L_nomix
    s_cmp_ge_u32 s3, 1
    s_cbranch_scc1 L_nomix
    buffer_store_dwordx4 v[160:163], v34, s[44:47], s71 offen sc1
L_nomix:
    v_and_b32 v36, s78, v36
    v_and_b32 v37, s78, v37
    v_and_b32 v38, s78, v38
    v_and_b32 v39, s78, v39
    v_add_f32_dpp v36, v36, v36 row_ror:8 row_mask:0xf bank_mask:0xf
    v_add_f32_dpp v37, v37, v37 row_ror:8 row_mask:0xf bank_mask:0xf
    v_add_f32_dpp v38, v38, v38 row_ror:8 row_mask:0xf bank_mask:0xf
    v_add_f32_dpp v39, v39, v39 row_ror:8 row_mask:0xf bank_mask:0xf
    v_mov_b32 v40, v36
    v_mov_b32 v41, v37
    v_mov_b32 v42, v38
    v_mov_b32 v43, v39
    v_permlane16_swap_b32 v36, v40
    v_permlane16_swap_b32 v37, v41
    v_permlane16_swap_b32 v38, v42
    v_permlane16_swap_b32 v39, v43
    v_add_f32 v36, v36, v40
    v_add_f32 v37, v37, v41
    v_add_f32 v38, v38, v42
    v_add_f32 v39, v39, v43
    v_mov_b32 v40, v36
    v_mov_b32 v41, v37
    v_mov_b32 v42, v38
    v_mov_b32 v43, v39
    v_permlane32_swap_b32 v36, v40
    v_permlane32_swap_b32 v37, v41
    v_permlane32_swap_b32 v38, v42
    v_permlane32_swap_b32 v39, v43
    v_add_f32 v36, v36, v40
    v_add_f32 v37, v37, v41
    v_add_f32 v38, v38, v42
    v_add_f32 v39, v39, v43
    v_cvt_pk_bf16_f32 v40, v36, v37
    v_cvt_pk_bf16_f32 v41, v38, v39
    v_lshlrev_b32 v28, 1, v0
    s_lshl_b32 s60, s3, 6
    v_add_u32 v28, s60, v28
    s_mov_b64 exec, 0xff
    ds_write_b16 v28, v40 offset:64
    ds_write_b16_d16_hi v28, v40 offset:80
    ds_write_b16 v28, v41 offset:96
    ds_write_b16_d16_hi v28, v41 offset:112
    s_waitcnt lgkmcnt(0)
    s_mov_b64 exec, 1
    v_mov_b32 v26, 0
    v_mov_b32 v27, 1
    ds_add_u32 v26, v27 offset:8
    s_mov_b64 exec, -1
    s_setprio 0
    buffer_load_dwordx4 v[128:131], v94, s[12:15], s97 offen nt
    s_add_u32 s97, s97, 13824
    buffer_load_dwordx4 v[132:135], v94, s[12:15], s97 offen nt
    buffer_load_dwordx4 v[208:211], v35, s[56:59], s98 offen nt
    s_add_u32 s98, s98, 5120
    v_mfma_f32_16x16x32_bf16 v[156:159], v[116:119], v[136:139], 0
    v_mfma_f32_16x16x32_bf16 v[156:159], v[120:123], v[140:143], v[156:159]
    v_mfma_f32_16x16x32_bf16 v[156:159], v[124:127], v[144:147], v[156:159]
    s_waitcnt vmcnt(2)
    buffer_load_dwordx4 v[212:215], v35, s[56:59], s98 offen nt
    s_add_u32 s98, s98, 5120
    v_mfma_f32_16x16x32_bf16 v[156:159], v[128:131], v[148:151], v[156:159]
    s_waitcnt vmcnt(2)
    buffer_load_dwordx4 v[216:219], v35, s[56:59], s98 offen nt
    s_add_u32 s98, s98, 5120
    v_mfma_f32_16x16x32_bf16 v[156:159], v[132:135], v[152:155], v[156:159]
    s_nop 7
    ds_write_b128 v25, v[156:159] offset:8192
    s_waitcnt lgkmcnt(0)
    s_mov_b64 exec, 1
    v_mov_b32 v26, 0
    v_mov_b32 v27, 1
    ds_add_u32 v26, v27 offset:4
    s_mov_b64 exec, -1
    v_mov_b32 v26, 0
    s_mov_b32 s79, 800000
L_wh4:
    ds_read_b32 v27, v26 offset:4
    s_waitcnt lgkmcnt(0)
    v_cmp_ne_u32 vcc, 4, v27
    s_cbranch_vccz L_wh4_done
    s_sub_u32 s79, s79, 1
    s_cbranch_scc0 L_wh4
L_wh4_done:
    s_cmp_lg_u32 s3, 1
    s_cbranch_scc1 L_pubh_done
    ds_read_b128 v[36:39], v24 offset:8192
    ds_read_b128 v[40:43], v24 offset:9216
    ds_read_b128 v[44:47], v24 offset:10240
    ds_read_b128 v[48:51], v24 offset:11264
    s_waitcnt lgkmcnt(0)
    v_add_f32 v36, v36, v40
    v_add_f32 v44, v44, v48
    v_add_f32 v37, v37, v41
    v_add_f32 v45, v45, v49
    v_add_f32 v38, v38, v42
    v_add_f32 v46, v46, v50
    v_add_f32 v39, v39, v43
    v_add_f32 v47, v47, v51
    v_add_f32 v160, v36, v44
    v_add_f32 v161, v37, v45
    v_add_f32 v162, v38, v46
    v_add_f32 v163, v39, v47
    v_add_u32 v160, 0x20, v160
    v_add_u32 v161, 0x20, v161
    v_add_u32 v162, 0x20, v162
    v_add_u32 v163, 0x20, v163
    v_and_or_b32 v160, v160, s78, v53
    v_and_or_b32 v161, v161, s78, v53
    v_and_or_b32 v162, v162, s78, v53
    v_and_or_b32 v163, v163, s78, v53
    s_add_u32 s71, s61, 0x40000
    s_mov_b32 exec_hi, 0
    s_cmp_ge_u32 s4, 27
    s_cbranch_scc1 L_pubh_done
    s_cmp_lg_u32 s72, 0
    s_cbranch_scc1 L_pubh_dev
    buffer_store_dwordx4 v[160:163], v34, s[44:47], s71 offen
    s_branch L_pubh_done
L_pubh_dev:
    buffer_store_dwordx4 v[160:163], v34, s[44:47], s71 offen sc1
L_pubh_done:
    s_mov_b64 exec, -1
    s_mov_b32 s12, s24
    s_and_b32 s13, s25, 0xffff
    s_mov_b32 s14, 0x500000
    s_mov_b32 s15, 0x20000
    s_waitcnt vmcnt(2)
    buffer_load_dwordx4 v[220:223], v35, s[56:59], s98 offen nt
    s_lshr_b32 s60, s3, 1
    s_lshl_b32 s60, s60, 7
    s_and_b32 s62, s3, 1
    s_lshl_b32 s62, s62, 3
    s_add_u32 s62, s62, s60
    s_add_u32 s62, s62, s70
    s_add_u32 s62, s62, 0x40000
    s_cmp_ge_u32 s4, 27
    s_cbranch_scc1 L_pollh_done
    s_mov_b32 s79, 40000
L_pollh:
    buffer_load_dwordx2 v[36:37], v95, s[44:47], s62 offen sc1
    buffer_load_dwordx2 v[38:39], v95, s[44:47], s62 offen offset:512 sc1
    s_waitcnt vmcnt(0)
    v_xor_b32 v36, v36, v53
    v_xor_b32 v37, v37, v53
    v_xor_b32 v38, v38, v53
    v_xor_b32 v39, v39, v53
    v_or3_b32 v26, v36, v37, v38
    v_or_b32 v26, v26, v39
    v_and_b32 v26, 0x3f, v26
    v_cmp_ne_u32 vcc, 0, v26
    s_cbranch_vccz L_pollh_done
    s_sub_u32 s79, s79, 1
    s_cbranch_scc0 L_pollh
L_pollh_done:
    buffer_load_dwordx4 v[176:179], v35, s[12:15], s99 offen nt
    s_add_u32 s99, s99, 5120
    buffer_load_dwordx4 v[180:183], v35, s[12:15], s99 offen nt
    s_add_u32 s99, s99, 5120
    buffer_load_dwordx4 v[184:187], v35, s[12:15], s99 offen nt
    s_add_u32 s99, s99, 5120
    v_add_f32_dpp v36, v36, v36 row_ror:8 row_mask:0xf bank_mask:0xf
    v_add_f32_dpp v37, v37, v37 row_ror:8 row_mask:0xf bank_mask:0xf
    v_add_f32_dpp v38, v38, v38 row_ror:8 row_mask:0xf bank_mask:0xf
    v_add_f32_dpp v39, v39, v39 row_ror:8 row_mask:0xf bank_mask:0xf
    v_mov_b32 v40, v36
    v_mov_b32 v41, v37
    v_mov_b32 v42, v38
    v_mov_b32 v43, v39
    v_permlane16_swap_b32 v36, v40
    v_permlane16_swap_b32 v37, v41
    v_permlane16_swap_b32 v38, v42
    v_permlane16_swap_b32 v39, v43
    v_add_f32 v36, v36, v40
    v_add_f32 v37, v37, v41
    v_add_f32 v38, v38, v42
    v_add_f32 v39, v39, v43
    v_mov_b32 v40, v36
    v_mov_b32 v41, v37
    v_mov_b32 v42, v38
    v_mov_b32 v43, v39
    v_permlane32_swap_b32 v36, v40
    v_permlane32_swap_b32 v37, v41
    v_permlane32_swap_b32 v38, v42
    v_permlane32_swap_b32 v39, v43
    v_add_f32 v36, v36, v40
    v_add_f32 v37, v37, v41
    v_add_f32 v38, v38, v42
    v_add_f32 v39, v39, v43
    v_and_b32 v26, 8, v0
    v_cmp_eq_u32 vcc, 0, v26
    s_nop 1
    v_cndmask_b32 v44, v38, v36, vcc
    v_cndmask_b32 v45, v39, v37, vcc
    v_cvt_pk_bf16_f32 v26, v44, v44
    v_and_b32 v44, 0xffff0000, v26
    v_mul_f32 v27, 0xbfb8aa3b, v44
    v_exp_f32 v27, v27
    s_nop 0
    v_add_f32 v27, 1.0, v27
    v_rcp_f32 v28, v27
    s_nop 0
    v_mul_f32 v29, v44, v28
    v_fma_f32 v30, -v29, v27, v44
    v_fma_f32 v30, v30, v28, v29
    v_cmp_gt_f32 vcc, 0x7f000000, v27
    s_nop 1
    v_cndmask_b32 v29, v29, v30, vcc
    v_cvt_pk_bf16_f32 v44, v29, v29
    v_cvt_pk_bf16_f32 v26, v45, v45
    v_and_b32 v45, 0xffff0000, v26
    v_mul_f32 v27, 0xbfb8aa3b, v45
    v_exp_f32 v27, v27
    s_nop 0
    v_add_f32 v27, 1.0, v27
    v_rcp_f32 v28, v27
    s_nop 0
    v_mul_f32 v29, v45, v28
    v_fma_f32 v30, -v29, v27, v45
    v_fma_f32 v30, v30, v28, v29
    v_cmp_gt_f32 vcc, 0x7f000000, v27
    s_nop 1
    v_cndmask_b32 v29, v29, v30, vcc
    v_cvt_pk_bf16_f32 v45, v29, v29
    v_lshrrev_b32 v26, 3, v3
    v_lshlrev_b32 v26, 5, v26
    v_lshl_add_u32 v26, v2, 2, v26
    ds_bpermute_b32 v48, v26, v44 offset:0
    ds_bpermute_b32 v49, v26, v44 offset:16
    ds_bpermute_b32 v50, v26, v45 offset:0
    ds_bpermute_b32 v51, v26, v45 offset:16
    s_waitcnt lgkmcnt(3)
    v_and_b32 v10, v48, v4
    v_and_b32 v11, v48, v5
    v_and_b32 v12, v48, v6
    v_and_b32 v13, v48, v7
    s_nop 1
    v_mfma_f32_16x16x32_bf16 v[18:21], v[208:211], v[10:13], 0
    s_waitcnt lgkmcnt(2)
    v_and_b32 v14, v49, v4
    v_and_b32 v15, v49, v5
    v_and_b32 v16, v49, v6
    v_and_b32 v17, v49, v7
    s_nop 1
    v_mfma_f32_16x16x32_bf16 v[18:21], v[212:215], v[14:17], v[18:21]
    s_waitcnt lgkmcnt(1)
    v_and_b32 v10, v50, v4
    v_and_b32 v11, v50, v5
    v_and_b32 v12, v50, v6
    v_and_b32 v13, v50, v7
    s_nop 1
    v_mfma_f32_16x16x32_bf16 v[18:21], v[216:219], v[10:13], v[18:21]
    s_waitcnt lgkmcnt(0)
    v_and_b32 v14, v51, v4
    v_and_b32 v15, v51, v5
    v_and_b32 v16, v51, v6
    v_and_b32 v17, v51, v7
    s_nop 1
    v_mfma_f32_16x16x32_bf16 v[18:21], v[220:223], v[14:17], v[18:21]
    s_nop 7
    ds_write_b128 v25, v[18:21] offset:16384
    s_waitcnt lgkmcnt(0)
    s_mov_b64 exec, 1
    v_mov_b32 v26, 0
    v_mov_b32 v27, 1
    ds_add_u32 v26, v27 offset:12
    s_mov_b64 exec, -1
    s_cmp_lg_u32 s3, 1
    s_cbranch_scc1 L_pubf_done
    v_mov_b32 v26, 0
    s_mov_b32 s79, 800000
L_wf4:
    ds_read_b32 v27, v26 offset:12
    s_waitcnt lgkmcnt(0)
    v_cmp_ne_u32 vcc, 4, v27
    s_cbranch_vccz L_wf4_done
    s_sub_u32 s79, s79, 1
    s_cbranch_scc0 L_wf4
L_wf4_done:
    ds_read_b128 v[36:39], v24 offset:16384
    ds_read_b128 v[40:43], v24 offset:17408
    ds_read_b128 v[44:47], v24 offset:18432
    ds_read_b128 v[48:51], v24 offset:19456
    s_waitcnt lgkmcnt(0)
    v_add_f32 v36, v36, v40
    v_add_f32 v44, v44, v48
    v_add_f32 v37, v37, v41
    v_add_f32 v45, v45, v49
    v_add_f32 v38, v38, v42
    v_add_f32 v46, v46, v50
    v_add_f32 v39, v39, v43
    v_add_f32 v47, v47, v51
    v_add_f32 v160, v36, v44
    v_add_f32 v161, v37, v45
    v_add_f32 v162, v38, v46
    v_add_f32 v163, v39, v47
    v_add_u32 v160, 0x20, v160
    v_add_u32 v161, 0x20, v161
    v_add_u32 v162, 0x20, v162
    v_add_u32 v163, 0x20, v163
    v_and_or_b32 v160, v160, s78, v53
    v_and_or_b32 v161, v161, s78, v53
    v_and_or_b32 v162, v162, s78, v53
    v_and_or_b32 v163, v163, s78, v53
    s_add_u32 s60, s61, 0x100000
    s_mov_b32 exec_hi, 0xffff
    s_cmp_ge_u32 s4, 27
    s_cbranch_scc1 L_pubf_done
    buffer_store_dwordx4 v[160:163], v34, s[44:47], s60 offen sc1
L_pubf_done:
    s_mov_b64 exec, -1
    s_waitcnt vmcnt(2)
    buffer_load_dwordx4 v[188:191], v35, s[12:15], s99 offen nt
    s_add_u32 s99, s99, 5120
    s_waitcnt vmcnt(2)
    buffer_load_dwordx4 v[192:195], v35, s[12:15], s99 offen nt
    s_add_u32 s99, s99, 5120
    s_waitcnt vmcnt(2)
    buffer_load_dwordx4 v[196:199], v35, s[12:15], s99 offen nt
    s_add_u32 s99, s99, 5120
    s_waitcnt vmcnt(2)
    buffer_load_dwordx4 v[200:203], v35, s[12:15], s99 offen nt
    s_add_u32 s99, s99, 5120
    s_waitcnt vmcnt(2)
    buffer_load_dwordx4 v[204:207], v35, s[12:15], s99 offen nt
    s_mov_b32 s52, s32
    s_and_b32 s53, s33, 0xffff
    s_mov_b32 s54, 0xa00
    s_mov_b32 s55, 0x20000
    s_lshr_b32 s100, s2, 3
    s_and_b32 s101, s2, 7
    s_lshr_b32 s75, s100, 1
    s_and_b32 s76, s100, 1
    s_lshl_b32 s74, s101, 10
    s_lshl_b32 s60, s76, 9
    s_add_u32 s74, s74, s60
    s_lshl_b32 s60, s75, 7
    s_add_u32 s74, s74, s60
    v_lshrrev_b32 v26, 3, v0
    v_lshlrev_b32 v27, 13, v26
    v_and_b32 v28, 7, v0
    v_lshlrev_b32 v29, 4, v28
    v_add_u32 v52, v27, v29
    s_mul_i32 s77, s76, 1280
    s_mul_i32 s60, s101, 160
    s_add_u32 s77, s77, s60
    s_lshl_b32 s60, s75, 6
    s_add_u32 s77, s77, s60
    v_lshlrev_b32 v58, 1, v28
    v_lshrrev_b32 v29, 4, v0
    v_lshlrev_b32 v29, 1, v29
    v_lshl_add_u32 v58, v28, 3, v29
    buffer_load_ushort v54, v58, s[40:43], s77 offen
    s_cmp_eq_u32 s75, 2
    s_mov_b32 s75, 0xf000f
    s_cselect_b32 s75, s75, 0xff00ff
    v_lshrrev_b32 v29, 4, v0
    s_lshl_b32 s60, s3, 5
    v_add_u32 v29, s60, v29
    v_mul_u32_u24 v29, 160, v29
    v_lshl_add_u32 v29, v3, 4, v29
    v_cmp_gt_u32 vcc, 10, v3
    s_waitcnt vmcnt(0)
    s_mov_b64 exec, vcc
    ds_write_b128 v29, v[176:179] offset:24576
    ds_write_b128 v29, v[180:183] offset:25216
    ds_write_b128 v29, v[184:187] offset:25856
    ds_write_b128 v29, v[188:191] offset:26496
    ds_write_b128 v29, v[192:195] offset:27136
    ds_write_b128 v29, v[196:199] offset:27776
    ds_write_b128 v29, v[200:203] offset:28416
    ds_write_b128 v29, v[204:207] offset:29056
    s_mov_b64 exec, -1
    s_waitcnt lgkmcnt(0)
    s_mov_b64 exec, 1
    v_mov_b32 v26, 0
    v_mov_b32 v27, 1
    ds_add_u32 v26, v27 offset:20
    s_mov_b64 exec, -1
    s_cmp_lg_u32 s3, 2
    s_cbranch_scc1 L_redf_skip
    s_cmp_ge_u32 s100, 6
    s_cbranch_scc1 L_redf_skip
    s_add_u32 s62, s74, 0x100000
    s_add_u32 s63, s62, 0x10000
    s_add_u32 s64, s62, 0x20000
    s_add_u32 s65, s62, 0x30000
    v_mov_b32 v112, 0x80000000
    v_cmp_gt_u32 vcc, 24, v0
    s_nop 1
    v_cndmask_b32 v112, v112, v52, vcc
    v_cmp_gt_u32 s[66:67], 24, v0
    s_mov_b32 s79, 40000
L_redf:
    buffer_load_dwordx4 v[96:99], v52, s[44:47], s62 offen sc1
    buffer_load_dwordx4 v[100:103], v52, s[44:47], s63 offen sc1
    buffer_load_dwordx4 v[104:107], v52, s[44:47], s64 offen sc1
    buffer_load_dwordx4 v[108:111], v112, s[44:47], s65 offen sc1
    s_waitcnt vmcnt(0)
    v_cndmask_b32 v108, v53, v108, s[66:67]
    v_cndmask_b32 v109, v53, v109, s[66:67]
    v_cndmask_b32 v110, v53, v110, s[66:67]
    v_cndmask_b32 v111, v53, v111, s[66:67]
    v_xor_b32 v96, v96, v53
    v_xor_b32 v97, v97, v53
    v_xor_b32 v98, v98, v53
    v_xor_b32 v99, v99, v53
    v_xor_b32 v100, v100, v53
    v_xor_b32 v101, v101, v53
    v_xor_b32 v102, v102, v53
    v_xor_b32 v103, v103, v53
    v_xor_b32 v104, v104, v53
    v_xor_b32 v105, v105, v53
    v_xor_b32 v106, v106, v53
    v_xor_b32 v107, v107, v53
    v_xor_b32 v108, v108, v53
    v_xor_b32 v109, v109, v53
    v_xor_b32 v110, v110, v53
    v_xor_b32 v111, v111, v53
    v_or3_b32 v26, v96, v97, v98
    v_or3_b32 v26, v26, v99, v100
    v_or3_b32 v26, v26, v101, v102
    v_or3_b32 v26, v26, v103, v104
    v_or3_b32 v26, v26, v105, v106
    v_or3_b32 v26, v26, v107, v108
    v_or3_b32 v26, v26, v109, v110
    v_or_b32 v26, v26, v111
    v_and_b32 v26, 0x3f, v26
    v_cmp_ne_u32 vcc, 0, v26
    s_cbranch_vccz L_redf_done
    s_sub_u32 s79, s79, 1
    s_cbranch_scc0 L_redf
L_redf_done:
    v_add_f32 v96, v96, v100
    v_add_f32 v104, v104, v108
    v_add_f32 v97, v97, v101
    v_add_f32 v105, v105, v109
    v_add_f32 v98, v98, v102
    v_add_f32 v106, v106, v110
    v_add_f32 v99, v99, v103
    v_add_f32 v107, v107, v111
    v_add_f32 v96, v96, v104
    v_add_f32 v98, v98, v106
    v_add_f32 v97, v97, v105
    v_add_f32 v99, v99, v107
    v_permlane32_swap_b32 v96, v98
    s_nop 0
    v_permlane32_swap_b32 v97, v99
    v_add_f32 v96, v96, v98
    v_add_f32 v97, v97, v99
    s_nop 1
    v_permlane16_swap_b32 v96, v97
    v_add_f32 v224, v96, v97
    s_nop 1
    v_add_f32_dpp v224, v224, v224 row_ror:8 row_mask:0xf bank_mask:0xf
    v_cvt_pk_bf16_f32 v26, v224, v224
    v_and_b32 v224, 0xffff0000, v26
    v_and_b32 v26, 6, v0
    v_lshlrev_b32 v26, 3, v26
    v_and_b32 v27, 1, v0
    v_lshl_add_u32 v26, v27, 2, v26
    v_lshrrev_b32 v27, 4, v0
    v_add_u32 v26, v26, v27
    v_lshlrev_b32 v26, 2, v26
    ds_bpermute_b32 v224, v26, v224
    s_waitcnt lgkmcnt(0)
L_redf_skip:
    v_and_b32 v26, 31, v0
    v_lshlrev_b32 v26, 4, v26
    v_mov_b32 v27, 0
    v_lshrrev_b32 v30, 5, v0
    v_lshlrev_b32 v30, 12, v30
    v_and_b32 v31, 31, v0
    v_lshlrev_b32 v31, 2, v31
    s_lshl_b32 s60, s3, 7
    v_add3_u32 v31, v30, v31, s60
    v_and_b32 v32, 15, v0
    v_lshl_add_u32 v30, v32, 3, v30
    v_add_u32 v30, s60, v30
    v_lshlrev_b32 v62, 2, v0
    v_add_u32 v62, s60, v62
    v_add_u32 v60, 0x200, v62
    v_mov_b32 v61, 0x5000
    v_add_u32 v33, 384, v62
    v_cmp_gt_u32 vcc, 32, v0
    s_nop 1
    v_cndmask_b32 v62, v33, v62, vcc
    v_mov_b32 v33, 0x5004
    v_cndmask_b32 v60, v33, v60, vcc
    s_mov_b32 s96, 0
    s_mov_b32 s97, 0x55555555
    s_mov_b32 s98, 0x3fb8aa3b
    v_mov_b32 v33, 0x80000000
    v_cndmask_b32 v62, v33, v62, vcc
    v_mov_b32 v61, 0x5700
    v_mov_b32 v32, 0
    s_mov_b32 s79, 800000
L_wt4:
    ds_read_b32 v33, v32 offset:20
    s_waitcnt lgkmcnt(0)
    v_cmp_ne_u32 vcc, 4, v33
    s_cbranch_vccz L_wt4_done
    s_sub_u32 s79, s79, 1
    s_cbranch_scc0 L_wt4
L_wt4_done:
    s_min_u32 s64, s3, 2
    s_cmp_eq_u32 s3, 2
    s_cbranch_scc1 L_wt_done
    v_mul_u32_u24 v33, 320, v2
    v_lshl_add_u32 v33, v3, 1, v33
    s_lshl_b32 s65, s64, 6
    v_add_u32 v33, s65, v33
    ds_read_u16 v164, v33 offset:24576
    ds_read_u16 v165, v33 offset:25856
    ds_read_u16 v166, v33 offset:27136
    ds_read_u16 v167, v33 offset:28416
    ds_read_u16 v168, v33 offset:24736
    ds_read_u16 v169, v33 offset:26016
    ds_read_u16 v170, v33 offset:27296
    ds_read_u16 v171, v33 offset:28576
    s_waitcnt lgkmcnt(0)
    v_lshl_or_b32 v176, v165, 16, v164
    v_lshl_or_b32 v177, v167, 16, v166
    v_lshl_or_b32 v178, v169, 16, v168
    v_lshl_or_b32 v179, v171, 16, v170
    ds_read_u16 v164, v33 offset:29696
    ds_read_u16 v165, v33 offset:30976
    ds_read_u16 v166, v33 offset:32256
    ds_read_u16 v167, v33 offset:33536
    ds_read_u16 v168, v33 offset:29856
    ds_read_u16 v169, v33 offset:31136
    ds_read_u16 v170, v33 offset:32416
    ds_read_u16 v171, v33 offset:33696
    s_waitcnt lgkmcnt(0)
    v_lshl_or_b32 v180, v165, 16, v164
    v_lshl_or_b32 v181, v167, 16, v166
    v_lshl_or_b32 v182, v169, 16, v168
    v_lshl_or_b32 v183, v171, 16, v170
    ds_read_u16 v164, v33 offset:34816
    ds_read_u16 v165, v33 offset:36096
    ds_read_u16 v166, v33 offset:37376
    ds_read_u16 v167, v33 offset:38656
    ds_read_u16 v168, v33 offset:34976
    ds_read_u16 v169, v33 offset:36256
    ds_read_u16 v170, v33 offset:37536
    ds_read_u16 v171, v33 offset:38816
    s_waitcnt lgkmcnt(0)
    v_lshl_or_b32 v184, v165, 16, v164
    v_lshl_or_b32 v185, v167, 16, v166
    v_lshl_or_b32 v186, v169, 16, v168
    v_lshl_or_b32 v187, v171, 16, v170
    ds_read_u16 v164, v33 offset:39936
    ds_read_u16 v165, v33 offset:41216
    ds_read_u16 v166, v33 offset:42496
    ds_read_u16 v167, v33 offset:43776
    ds_read_u16 v168, v33 offset:40096
    ds_read_u16 v169, v33 offset:41376
    ds_read_u16 v170, v33 offset:42656
    ds_read_u16 v171, v33 offset:43936
    s_waitcnt lgkmcnt(0)
    v_lshl_or_b32 v188, v165, 16, v164
    v_lshl_or_b32 v189, v167, 16, v166
    v_lshl_or_b32 v190, v169, 16, v168
    v_lshl_or_b32 v191, v171, 16, v170
    s_cmp_eq_u32 s3, 3
    s_cbranch_scc1 L_wt_pad
    ds_read_u16 v164, v33 offset:24608
    ds_read_u16 v165, v33 offset:25888
    ds_read_u16 v166, v33 offset:27168
    ds_read_u16 v167, v33 offset:28448
    ds_read_u16 v168, v33 offset:24768
    ds_read_u16 v169, v33 offset:26048
    ds_read_u16 v170, v33 offset:27328
    ds_read_u16 v171, v33 offset:28608
    s_waitcnt lgkmcnt(0)
    v_lshl_or_b32 v192, v165, 16, v164
    v_lshl_or_b32 v193, v167, 16, v166
    v_lshl_or_b32 v194, v169, 16, v168
    v_lshl_or_b32 v195, v171, 16, v170
    ds_read_u16 v164, v33 offset:29728
    ds_read_u16 v165, v33 offset:31008
    ds_read_u16 v166, v33 offset:32288
    ds_read_u16 v167, v33 offset:33568
    ds_read_u16 v168, v33 offset:29888
    ds_read_u16 v169, v33 offset:31168
    ds_read_u16 v170, v33 offset:32448
    ds_read_u16 v171, v33 offset:33728
    s_waitcnt lgkmcnt(0)
    v_lshl_or_b32 v196, v165, 16, v164
    v_lshl_or_b32 v197, v167, 16, v166
    v_lshl_or_b32 v198, v169, 16, v168
    v_lshl_or_b32 v199, v171, 16, v170
    ds_read_u16 v164, v33 offset:34848
    ds_read_u16 v165, v33 offset:36128
    ds_read_u16 v166, v33 offset:37408
    ds_read_u16 v167, v33 offset:38688
    ds_read_u16 v168, v33 offset:35008
    ds_read_u16 v169, v33 offset:36288
    ds_read_u16 v170, v33 offset:37568
    ds_read_u16 v171, v33 offset:38848
    s_waitcnt lgkmcnt(0)
    v_lshl_or_b32 v200, v165, 16, v164
    v_lshl_or_b32 v201, v167, 16, v166
    v_lshl_or_b32 v202, v169, 16, v168
    v_lshl_or_b32 v203, v171, 16, v170
    ds_read_u16 v164, v33 offset:39968
    ds_read_u16 v165, v33 offset:41248
    ds_read_u16 v166, v33 offset:42528
    ds_read_u16 v167, v33 offset:43808
    ds_read_u16 v168, v33 offset:40128
    ds_read_u16 v169, v33 offset:41408
    ds_read_u16 v170, v33 offset:42688
    ds_read_u16 v171, v33 offset:43968
    s_waitcnt lgkmcnt(0)
    v_lshl_or_b32 v204, v165, 16, v164
    v_lshl_or_b32 v205, v167, 16, v166
    v_lshl_or_b32 v206, v169, 16, v168
    v_lshl_or_b32 v207, v171, 16, v170
    s_branch L_wt_done
L_wt_pad:
    v_mov_b32 v192, 0
    v_mov_b32 v193, 0
    v_mov_b32 v194, 0
    v_mov_b32 v195, 0
    v_mov_b32 v196, 0
    v_mov_b32 v197, 0
    v_mov_b32 v198, 0
    v_mov_b32 v199, 0
    v_mov_b32 v200, 0
    v_mov_b32 v201, 0
    v_mov_b32 v202, 0
    v_mov_b32 v203, 0
    v_mov_b32 v204, 0
    v_mov_b32 v205, 0
    v_mov_b32 v206, 0
    v_mov_b32 v207, 0
L_wt_done:
    v_lshrrev_b32 v65, 5, v0
    v_lshlrev_b32 v65, 8, v65
    v_and_b32 v33, 31, v0
    v_lshl_add_u32 v65, v33, 1, v65
    s_lshl_b32 s65, s3, 6
    v_add_u32 v65, s65, v65
    v_and_b32 v66, 4, v0
    v_lshlrev_b32 v66, 6, v66
    v_lshl_add_u32 v66, v2, 4, v66
    v_and_b32 v67, 1, v2
    v_lshlrev_b32 v67, 9, v67
    v_lshrrev_b32 v33, 5, v0
    v_lshl_add_u32 v67, v33, 6, v67
    v_lshl_add_u32 v67, v3, 2, v67
    s_lshl_b32 s65, s64, 7
    v_add_u32 v67, s65, v67
    s_mov_b32 s64, 0
    s_mov_b32 s65, -1
    s_cmp_lg_u32 s3, 3
    s_cbranch_scc1 L_es_end
    v_mov_b32 v104, 0
    s_mov_b32 s79, 800000
L_es_cnt:
    ds_read_b32 v105, v104 offset:28
    s_waitcnt lgkmcnt(0)
    v_cmp_ne_u32 vcc, 4, v105
    s_cbranch_vccz L_es_cnt_done
    s_sub_u32 s79, s79, 1
    s_cbranch_scc0 L_es_cnt
L_es_cnt_done:
    ds_read_b64 v[96:97], v104 offset:20480
    ds_read_b64 v[98:99], v104 offset:20992
    ds_read_b64 v[100:101], v104 offset:21504
    ds_read_b64 v[102:103], v104 offset:22016
    s_lshl_b32 s48, s7, 7
    s_add_u32 s48, s48, 0x150000
    s_and_b32 s49, s7, 0xfc
    s_lshl_b32 s49, s49, 7
    s_add_u32 s49, s49, 0x150000
    s_waitcnt lgkmcnt(0)
    v_max3_f32 v106, v96, v98, v100
    v_max_f32 v106, v106, v102
    v_add_u32 v106, 0x20, v106
    v_and_b32 v106, s78, v106
    v_sub_f32 v108, v96, v106
    v_sub_f32 v109, v98, v106
    v_sub_f32 v110, v100, v106
    v_sub_f32 v111, v102, v106
    v_mul_f32 v108, s98, v108
    v_mul_f32 v109, s98, v109
    v_mul_f32 v110, s98, v110
    v_mul_f32 v111, s98, v111
    v_exp_f32 v108, v108
    v_exp_f32 v109, v109
    v_exp_f32 v110, v110
    v_exp_f32 v111, v111
    v_mul_f32 v107, v108, v97
    v_fmac_f32 v107, v109, v99
    v_fmac_f32 v107, v110, v101
    v_fmac_f32 v107, v111, v103
    v_add_u32 v107, 0x20, v107
    v_and_b32 v112, 1, v0
    v_cmp_eq_u32 vcc, 1, v112
    s_nop 1
    v_cndmask_b32 v107, v106, v107, vcc
    v_and_or_b32 v107, v107, s78, v53
    v_lshlrev_b32 v112, 2, v0
    v_lshlrev_b32 v113, 3, v0
    s_mov_b32 exec_hi, 0
    s_cmp_lg_u32 s72, 0
    s_cbranch_scc1 L_es_dev
    buffer_store_dword v107, v112, s[44:47], s48 offen
    s_branch L_es_st
L_es_dev:
    buffer_store_dword v107, v112, s[44:47], s48 offen sc1
L_es_st:
    s_mov_b64 exec, -1
    s_mov_b32 s79, 40000
L_es_poll:
    buffer_load_dwordx2 v[114:115], v113, s[44:47], s49 offen sc1
    s_waitcnt vmcnt(0)
    v_xor_b32 v114, v114, v53
    v_xor_b32 v115, v115, v53
    v_or_b32 v116, v114, v115
    v_and_b32 v116, 0x3f, v116
    v_cmp_ne_u32 vcc, 0, v116
    s_cbranch_vccz L_es_poll_done
    s_sub_u32 s79, s79, 1
    s_cbranch_scc0 L_es_poll
L_es_poll_done:
    v_mov_b32 v117, v114
    v_mov_b32 v118, v117
    s_nop 1
    v_permlane16_swap_b32 v117, v118
    v_max_f32 v117, v117, v118
    v_mov_b32 v118, v117
    s_nop 1
    v_permlane32_swap_b32 v117, v118
    v_max_f32 v117, v117, v118
    v_sub_f32 v114, v114, v117
    v_mul_f32 v114, s98, v114
    v_exp_f32 v114, v114
    s_nop 0
    v_mul_f32 v114, v114, v115
    v_mov_b32 v118, v114
    s_nop 1
    v_permlane16_swap_b32 v114, v118
    v_add_f32 v114, v114, v118
    v_mov_b32 v118, v114
    s_nop 1
    v_permlane32_swap_b32 v114, v118
    v_add_f32 v114, v114, v118
    v_rcp_f32 v115, v114
    s_nop 0
    v_fma_f32 v116, -v114, v115, 1.0
    v_fma_f32 v115, v116, v115, v115
    v_sub_f32 v108, v96, v117
    v_sub_f32 v109, v98, v117
    v_sub_f32 v110, v100, v117
    v_sub_f32 v111, v102, v117
    v_mul_f32 v108, s98, v108
    v_mul_f32 v109, s98, v109
    v_mul_f32 v110, s98, v110
    v_mul_f32 v111, s98, v111
    v_exp_f32 v108, v108
    v_exp_f32 v109, v109
    v_exp_f32 v110, v110
    v_exp_f32 v111, v111
    v_mul_f32 v108, v108, v115
    v_mul_f32 v109, v109, v115
    v_mul_f32 v110, v110, v115
    v_mul_f32 v111, v111, v115
    v_mov_b32 v104, 0x5700
    s_mov_b64 exec, 1
    ds_write_b128 v104, v[108:111]
    s_mov_b64 exec, -1
L_es_end:
    v_lshrrev_b32 v32, 3, v3
    v_lshlrev_b32 v32, 7, v32
    v_lshlrev_b32 v33, 4, v2
    v_add_u32 v32, v32, v33
    s_add_u32 s62, s70, 0x80000
    s_add_u32 s63, s61, 0x80000
    s_waitcnt vmcnt(0) lgkmcnt(0)
    v_lshlrev_b32 v54, 16, v54
    s_setprio 3
    s_barrier
    ds_read_b128 v[36:39], v61
    ds_read2st64_b32 v[96:97], v60 offset0:0 offset1:2
    ds_read2st64_b32 v[98:99], v60 offset0:4 offset1:6
    s_waitcnt lgkmcnt(0)
    v_mul_f32 v44, v36, v96
    v_fmac_f32 v44, v37, v97
    v_fmac_f32 v44, v38, v98
    v_fmac_f32 v44, v39, v99
    v_add_u32 v44, 0x20, v44
    v_and_or_b32 v44, v44, s78, v53
    s_cmp_lg_u32 s72, 0
    s_cbranch_scc1 L_apdev
    buffer_store_dword v44, v62, s[44:47], s63 offen
    s_branch L_gatherA
L_apdev:
    buffer_store_dword v44, v62, s[44:47], s63 offen sc1
L_gatherA:
    s_mov_b32 s79, 40000
L_pollA:
    buffer_load_dword v96, v31, s[44:47], s62 offen offset:0 sc1
    buffer_load_dword v97, v31, s[44:47], s62 offen offset:1024 sc1
    buffer_load_dword v98, v31, s[44:47], s62 offen offset:2048 sc1
    buffer_load_dword v99, v31, s[44:47], s62 offen offset:3072 sc1
    s_waitcnt vmcnt(0)
    v_xor_b32 v96, v96, v53
    v_xor_b32 v97, v97, v53
    v_xor_b32 v98, v98, v53
    v_xor_b32 v99, v99, v53
    v_or3_b32 v28, v96, v97, v98
    v_or_b32 v28, v28, v99
    v_and_b32 v28, 0x3f, v28
    v_cmp_ne_u32 vcc, 0, v28
    s_cbranch_vccz L_pollA_done
    s_sub_u32 s79, s79, 1
    s_cbranch_scc0 L_pollA
L_pollA_done:
    v_add_f32 v96, v96, v97
    v_add_f32 v98, v98, v99
    v_add_f32 v96, v96, v98
    v_cvt_pk_bf16_f32 v27, v96, v96
    ds_write_b16 v65, v27 offset:22528
    s_add_u32 s62, s61, 0xc0000
    s_waitcnt lgkmcnt(0)
    s_barrier
    s_cmp_eq_u32 s3, 2
    s_cbranch_scc1 L_final
    ds_read_b128 v[112:115], v66 offset:22528
    ds_read_b128 v[116:119], v66 offset:22592
    ds_read_b128 v[120:123], v66 offset:22656
    ds_read_b128 v[124:127], v66 offset:22720
    s_waitcnt lgkmcnt(3)
    v_mfma_f32_16x16x32_bf16 v[18:21], v[112:115], v[176:179], 0
    v_mfma_f32_16x16x32_bf16 v[10:13], v[112:115], v[192:195], 0
    s_waitcnt lgkmcnt(2)
    v_mfma_f32_16x16x32_bf16 v[18:21], v[116:119], v[180:183], v[18:21]
    v_mfma_f32_16x16x32_bf16 v[10:13], v[116:119], v[196:199], v[10:13]
    s_waitcnt lgkmcnt(1)
    v_mfma_f32_16x16x32_bf16 v[18:21], v[120:123], v[184:187], v[18:21]
    v_mfma_f32_16x16x32_bf16 v[10:13], v[120:123], v[200:203], v[10:13]
    s_waitcnt lgkmcnt(0)
    v_mfma_f32_16x16x32_bf16 v[18:21], v[124:127], v[188:191], v[18:21]
    v_mfma_f32_16x16x32_bf16 v[10:13], v[124:127], v[204:207], v[10:13]
    s_nop 7
    v_cndmask_b32 v160, v18, v10, s[64:65]
    v_add_u32 v160, 0x20, v160
    v_and_or_b32 v160, v160, s78, v53
    buffer_store_dword v160, v67, s[44:47], s62 offen sc1
    s_branch L_hend
L_final:
    s_cmp_ge_u32 s100, 6
    s_cbranch_scc1 L_hend
    s_add_u32 s62, s74, 0xc0000
    s_add_u32 s63, s62, 0x10000
    s_add_u32 s64, s62, 0x20000
    s_add_u32 s65, s62, 0x30000
    s_mov_b64 s[48:49], -1
    s_mov_b64 s[50:51], -1
    s_mov_b64 s[66:67], -1
    s_mov_b64 s[68:69], -1
    buffer_load_dwordx4 v[96:99], v52, s[44:47], s62 offen sc1
    buffer_load_dwordx4 v[100:103], v52, s[44:47], s63 offen sc1
    buffer_load_dwordx4 v[104:107], v52, s[44:47], s64 offen sc1
    buffer_load_dwordx4 v[108:111], v52, s[44:47], s65 offen sc1
    buffer_load_dwordx4 v[112:115], v52, s[44:47], s62 offen sc1
    buffer_load_dwordx4 v[116:119], v52, s[44:47], s63 offen sc1
    buffer_load_dwordx4 v[120:123], v52, s[44:47], s64 offen sc1
    buffer_load_dwordx4 v[124:127], v52, s[44:47], s65 offen sc1
    s_mov_b32 s79, 40000
L_red:
    s_mov_b64 exec, s[48:49]
    buffer_load_dwordx4 v[128:131], v52, s[44:47], s62 offen sc1
    s_mov_b64 exec, s[50:51]
    buffer_load_dwordx4 v[132:135], v52, s[44:47], s63 offen sc1
    s_mov_b64 exec, s[66:67]
    buffer_load_dwordx4 v[136:139], v52, s[44:47], s64 offen sc1
    s_mov_b64 exec, s[68:69]
    buffer_load_dwordx4 v[140:143], v52, s[44:47], s65 offen sc1
    s_mov_b64 exec, s[48:49]
    s_waitcnt vmcnt(8)
    v_xor_b32 v144, v96, v53
    v_xor_b32 v145, v97, v53
    v_xor_b32 v146, v98, v53
    v_xor_b32 v147, v99, v53
    s_mov_b64 exec, s[50:51]
    v_xor_b32 v148, v100, v53
    v_xor_b32 v149, v101, v53
    v_xor_b32 v150, v102, v53
    v_xor_b32 v151, v103, v53
    s_mov_b64 exec, s[66:67]
    v_xor_b32 v152, v104, v53
    v_xor_b32 v153, v105, v53
    v_xor_b32 v154, v106, v53
    v_xor_b32 v155, v107, v53
    s_mov_b64 exec, s[68:69]
    v_xor_b32 v156, v108, v53
    v_xor_b32 v157, v109, v53
    v_xor_b32 v158, v110, v53
    v_xor_b32 v159, v111, v53
    s_mov_b64 exec, -1
    v_or3_b32 v26, v144, v145, v146
    v_or3_b32 v27, v148, v149, v150
    v_or3_b32 v28, v152, v153, v154
    v_or3_b32 v29, v156, v157, v158
    v_or_b32 v26, v26, v147
    v_or_b32 v27, v27, v151
    v_or_b32 v28, v28, v155
    v_or_b32 v29, v29, v159
    v_or3_b32 v30, v26, v27, v28
    v_or_b32 v30, v30, v29
    v_and_b32 v30, 0x3f, v30
    v_cmp_ne_u32 vcc, 0, v30
    s_cbranch_vccz L_red_done
    v_and_b32 v26, 0x3f, v26
    v_and_b32 v27, 0x3f, v27
    v_and_b32 v28, 0x3f, v28
    v_and_b32 v29, 0x3f, v29
    v_or_b32_dpp v26, v26, v26 quad_perm:[1,0,3,2] row_mask:0xf bank_mask:0xf
    v_or_b32_dpp v27, v27, v27 quad_perm:[1,0,3,2] row_mask:0xf bank_mask:0xf
    v_or_b32_dpp v28, v28, v28 quad_perm:[1,0,3,2] row_mask:0xf bank_mask:0xf
    v_or_b32_dpp v29, v29, v29 quad_perm:[1,0,3,2] row_mask:0xf bank_mask:0xf
    v_or_b32_dpp v26, v26, v26 quad_perm:[2,3,0,1] row_mask:0xf bank_mask:0xf
    v_or_b32_dpp v27, v27, v27 quad_perm:[2,3,0,1] row_mask:0xf bank_mask:0xf
    v_or_b32_dpp v28, v28, v28 quad_perm:[2,3,0,1] row_mask:0xf bank_mask:0xf
    v_or_b32_dpp v29, v29, v29 quad_perm:[2,3,0,1] row_mask:0xf bank_mask:0xf
    v_cmp_ne_u32 s[48:49], 0, v26
    v_cmp_ne_u32 s[50:51], 0, v27
    v_cmp_ne_u32 s[66:67], 0, v28
    v_cmp_ne_u32 s[68:69], 0, v29
    s_mov_b64 exec, s[48:49]
    buffer_load_dwordx4 v[96:99], v52, s[44:47], s62 offen sc1
    s_mov_b64 exec, s[50:51]
    buffer_load_dwordx4 v[100:103], v52, s[44:47], s63 offen sc1
    s_mov_b64 exec, s[66:67]
    buffer_load_dwordx4 v[104:107], v52, s[44:47], s64 offen sc1
    s_mov_b64 exec, s[68:69]
    buffer_load_dwordx4 v[108:111], v52, s[44:47], s65 offen sc1
    s_mov_b64 exec, s[48:49]
    s_waitcnt vmcnt(8)
    v_xor_b32 v144, v112, v53
    v_xor_b32 v145, v113, v53
    v_xor_b32 v146, v114, v53
    v_xor_b32 v147, v115, v53
    s_mov_b64 exec, s[50:51]
    v_xor_b32 v148, v116, v53
    v_xor_b32 v149, v117, v53
    v_xor_b32 v150, v118, v53
    v_xor_b32 v151, v119, v53
    s_mov_b64 exec, s[66:67]
    v_xor_b32 v152, v120, v53
    v_xor_b32 v153, v121, v53
    v_xor_b32 v154, v122, v53
    v_xor_b32 v155, v123, v53
    s_mov_b64 exec, s[68:69]
    v_xor_b32 v156, v124, v53
    v_xor_b32 v157, v125, v53
    v_xor_b32 v158, v126, v53
    v_xor_b32 v159, v127, v53
    s_mov_b64 exec, -1
    v_or3_b32 v26, v144, v145, v146
    v_or3_b32 v27, v148, v149, v150
    v_or3_b32 v28, v152, v153, v154
    v_or3_b32 v29, v156, v157, v158
    v_or_b32 v26, v26, v147
    v_or_b32 v27, v27, v151
    v_or_b32 v28, v28, v155
    v_or_b32 v29, v29, v159
    v_or3_b32 v30, v26, v27, v28
    v_or_b32 v30, v30, v29
    v_and_b32 v30, 0x3f, v30
    v_cmp_ne_u32 vcc, 0, v30
    s_cbranch_vccz L_red_done
    v_and_b32 v26, 0x3f, v26
    v_and_b32 v27, 0x3f, v27
    v_and_b32 v28, 0x3f, v28
    v_and_b32 v29, 0x3f, v29
    v_or_b32_dpp v26, v26, v26 quad_perm:[1,0,3,2] row_mask:0xf bank_mask:0xf
    v_or_b32_dpp v27, v27, v27 quad_perm:[1,0,3,2] row_mask:0xf bank_mask:0xf
    v_or_b32_dpp v28, v28, v28 quad_perm:[1,0,3,2] row_mask:0xf bank_mask:0xf
    v_or_b32_dpp v29, v29, v29 quad_perm:[1,0,3,2] row_mask:0xf bank_mask:0xf
    v_or_b32_dpp v26, v26, v26 quad_perm:[2,3,0,1] row_mask:0xf bank_mask:0xf
    v_or_b32_dpp v27, v27, v27 quad_perm:[2,3,0,1] row_mask:0xf bank_mask:0xf
    v_or_b32_dpp v28, v28, v28 quad_perm:[2,3,0,1] row_mask:0xf bank_mask:0xf
    v_or_b32_dpp v29, v29, v29 quad_perm:[2,3,0,1] row_mask:0xf bank_mask:0xf
    v_cmp_ne_u32 s[48:49], 0, v26
    v_cmp_ne_u32 s[50:51], 0, v27
    v_cmp_ne_u32 s[66:67], 0, v28
    v_cmp_ne_u32 s[68:69], 0, v29
    s_mov_b64 exec, s[48:49]
    buffer_load_dwordx4 v[112:115], v52, s[44:47], s62 offen sc1
    s_mov_b64 exec, s[50:51]
    buffer_load_dwordx4 v[116:119], v52, s[44:47], s63 offen sc1
    s_mov_b64 exec, s[66:67]
    buffer_load_dwordx4 v[120:123], v52, s[44:47], s64 offen sc1
    s_mov_b64 exec, s[68:69]
    buffer_load_dwordx4 v[124:127], v52, s[44:47], s65 offen sc1
    s_mov_b64 exec, s[48:49]
    s_waitcnt vmcnt(8)
    v_xor_b32 v144, v128, v53
    v_xor_b32 v145, v129, v53
    v_xor_b32 v146, v130, v53
    v_xor_b32 v147, v131, v53
    s_mov_b64 exec, s[50:51]
    v_xor_b32 v148, v132, v53
    v_xor_b32 v149, v133, v53
    v_xor_b32 v150, v134, v53
    v_xor_b32 v151, v135, v53
    s_mov_b64 exec, s[66:67]
    v_xor_b32 v152, v136, v53
    v_xor_b32 v153, v137, v53
    v_xor_b32 v154, v138, v53
    v_xor_b32 v155, v139, v53
    s_mov_b64 exec, s[68:69]
    v_xor_b32 v156, v140, v53
    v_xor_b32 v157, v141, v53
    v_xor_b32 v158, v142, v53
    v_xor_b32 v159, v143, v53
    s_mov_b64 exec, -1
    v_or3_b32 v26, v144, v145, v146
    v_or3_b32 v27, v148, v149, v150
    v_or3_b32 v28, v152, v153, v154
    v_or3_b32 v29, v156, v157, v158
    v_or_b32 v26, v26, v147
    v_or_b32 v27, v27, v151
    v_or_b32 v28, v28, v155
    v_or_b32 v29, v29, v159
    v_or3_b32 v30, v26, v27, v28
    v_or_b32 v30, v30, v29
    v_and_b32 v30, 0x3f, v30
    v_cmp_ne_u32 vcc, 0, v30
    s_cbranch_vccz L_red_done
    v_and_b32 v26, 0x3f, v26
    v_and_b32 v27, 0x3f, v27
    v_and_b32 v28, 0x3f, v28
    v_and_b32 v29, 0x3f, v29
    v_or_b32_dpp v26, v26, v26 quad_perm:[1,0,3,2] row_mask:0xf bank_mask:0xf
    v_or_b32_dpp v27, v27, v27 quad_perm:[1,0,3,2] row_mask:0xf bank_mask:0xf
    v_or_b32_dpp v28, v28, v28 quad_perm:[1,0,3,2] row_mask:0xf bank_mask:0xf
    v_or_b32_dpp v29, v29, v29 quad_perm:[1,0,3,2] row_mask:0xf bank_mask:0xf
    v_or_b32_dpp v26, v26, v26 quad_perm:[2,3,0,1] row_mask:0xf bank_mask:0xf
    v_or_b32_dpp v27, v27, v27 quad_perm:[2,3,0,1] row_mask:0xf bank_mask:0xf
    v_or_b32_dpp v28, v28, v28 quad_perm:[2,3,0,1] row_mask:0xf bank_mask:0xf
    v_or_b32_dpp v29, v29, v29 quad_perm:[2,3,0,1] row_mask:0xf bank_mask:0xf
    v_cmp_ne_u32 s[48:49], 0, v26
    v_cmp_ne_u32 s[50:51], 0, v27
    v_cmp_ne_u32 s[66:67], 0, v28
    v_cmp_ne_u32 s[68:69], 0, v29
    s_sub_u32 s79, s79, 1
    s_cbranch_scc0 L_red
L_red_done:
    v_add_f32 v144, v144, v148
    v_add_f32 v152, v152, v156
    v_add_f32 v145, v145, v149
    v_add_f32 v153, v153, v157
    v_add_f32 v146, v146, v150
    v_add_f32 v154, v154, v158
    v_add_f32 v147, v147, v151
    v_add_f32 v155, v155, v159
    v_add_f32 v144, v144, v152
    v_add_f32 v146, v146, v154
    v_add_f32 v145, v145, v153
    v_add_f32 v147, v147, v155
    v_permlane32_swap_b32 v144, v146
    s_nop 0
    v_permlane32_swap_b32 v145, v147
    v_add_f32 v144, v144, v146
    v_add_f32 v145, v145, v147
    s_nop 1
    v_permlane16_swap_b32 v144, v145
    v_add_f32 v36, v144, v145
    s_nop 1
    v_add_f32_dpp v36, v36, v36 row_ror:8 row_mask:0xf bank_mask:0xf
    v_cvt_pk_bf16_f32 v26, v36, v36
    v_and_b32 v36, 0xffff0000, v26
    v_add_f32 v36, v54, v36
    v_cvt_pk_bf16_f32 v26, v36, v36
    v_and_b32 v36, 0xffff0000, v26
    v_add_f32 v36, v36, v224
    v_cvt_pk_bf16_f32 v36, v36, v36
    s_mov_b32 exec_lo, s75
    s_mov_b32 exec_hi, s75
    buffer_store_short v36, v58, s[52:55], s77 offen
    s_cmp_lg_u32 s7, 0
    s_cbranch_scc1 L_hend
    s_mov_b64 exec, 1
    v_mov_b32 v26, 0
    s_mov_b32 s60, 0x140000
    buffer_store_dword v59, v26, s[44:47], s60 offen sc1
L_hend:
    s_mov_b64 exec, -1
    s_endpgm
L_stream:
    s_setprio 1
    s_lshl_b32 s60, s6, 25
    s_lshl_b32 s61, s4, 20
    s_add_u32 s60, s60, s61
    s_and_b32 s61, s5, 3
    s_lshl_b32 s61, s61, 18
    s_add_u32 s66, s60, s61
    s_sub_u32 s61, s3, 4
    s_lshl_b32 s62, s61, 10
    v_lshlrev_b32 v1, 4, v0
    v_add_u32 v1, s62, v1
    s_mul_i32 s60, s2, 9
    s_and_b32 s60, s60, 63
    s_lshl_b32 s60, s60, 12
    s_waitcnt lgkmcnt(0)
    s_add_u32 s8, s18, s66
    s_addc_u32 s9, s19, 0
    s_and_b32 s9, s9, 0xffff
    s_mov_b32 s10, 0x40000
    s_mov_b32 s11, 0x20000
    s_add_u32 s12, s20, s66
    s_addc_u32 s13, s21, 0
    s_and_b32 s13, s13, 0xffff
    s_mov_b32 s14, 0x40000
    s_mov_b32 s15, 0x20000
    buffer_load_dwordx4 v[48:51], v1, s[8:11], s60 offen nt
    s_add_u32 s60, s60, 4096
    s_and_b32 s60, s60, 0x3ffff
    buffer_load_dwordx4 v[52:55], v1, s[8:11], s60 offen nt
    s_add_u32 s60, s60, 4096
    s_and_b32 s60, s60, 0x3ffff
    buffer_load_dwordx4 v[56:59], v1, s[8:11], s60 offen nt
    s_add_u32 s60, s60, 4096
    s_and_b32 s60, s60, 0x3ffff
    buffer_load_dwordx4 v[60:63], v1, s[8:11], s60 offen nt
    s_add_u32 s60, s60, 4096
    s_and_b32 s60, s60, 0x3ffff
    v_and_b32 v30, 15, v0
    v_and_b32 v31, 1, v30
    v_lshlrev_b32 v31, 4, v31
    v_mov_b32 v32, 0xffff
    v_lshlrev_b32 v31, v31, v32
    v_lshrrev_b32 v33, 1, v30
    v_cmp_eq_u32 vcc, 0, v33
    s_nop 1
    v_cndmask_b32 v14, 0, v31, vcc
    v_cmp_eq_u32 vcc, 1, v33
    s_nop 1
    v_cndmask_b32 v15, 0, v31, vcc
    v_cmp_eq_u32 vcc, 2, v33
    s_nop 1
    v_cndmask_b32 v16, 0, v31, vcc
    v_cmp_eq_u32 vcc, 3, v33
    s_nop 1
    v_cndmask_b32 v17, 0, v31, vcc
    v_lshlrev_b32 v34, 4, v30
    s_mov_b32 s64, 0x00010001
    s_mov_b32 s65, 0x00010001
    buffer_load_dwordx4 v[64:67], v1, s[8:11], s60 offen nt
    s_add_u32 s60, s60, 4096
    s_and_b32 s60, s60, 0x3ffff
    buffer_load_dwordx4 v[68:71], v1, s[8:11], s60 offen nt
    s_add_u32 s60, s60, 4096
    s_and_b32 s60, s60, 0x3ffff
    s_waitcnt vmcnt(5)
    buffer_load_dwordx4 v[72:75], v1, s[8:11], s60 offen nt
    s_add_u32 s60, s60, 4096
    s_and_b32 s60, s60, 0x3ffff
    s_waitcnt vmcnt(5)
    buffer_load_dwordx4 v[76:79], v1, s[8:11], s60 offen nt
    s_add_u32 s60, s60, 4096
    s_and_b32 s60, s60, 0x3ffff
    s_waitcnt vmcnt(5)
    buffer_load_dwordx4 v[80:83], v1, s[8:11], s60 offen nt
    s_add_u32 s60, s60, 4096
    s_and_b32 s60, s60, 0x3ffff
    s_waitcnt vmcnt(5)
    buffer_load_dwordx4 v[84:87], v1, s[8:11], s60 offen nt
    s_add_u32 s60, s60, 4096
    s_and_b32 s60, s60, 0x3ffff
    s_waitcnt vmcnt(5)
    buffer_load_dwordx4 v[88:91], v1, s[8:11], s60 offen nt
    s_add_u32 s60, s60, 4096
    s_and_b32 s60, s60, 0x3ffff
    s_waitcnt vmcnt(5)
    buffer_load_dwordx4 v[92:95], v1, s[8:11], s60 offen nt
    s_add_u32 s60, s60, 4096
    s_and_b32 s60, s60, 0x3ffff
    s_waitcnt vmcnt(5)
    buffer_load_dwordx4 v[96:99], v1, s[8:11], s60 offen nt
    s_add_u32 s60, s60, 4096
    s_and_b32 s60, s60, 0x3ffff
    s_waitcnt vmcnt(5)
    buffer_load_dwordx4 v[100:103], v1, s[8:11], s60 offen nt
    s_add_u32 s60, s60, 4096
    s_and_b32 s60, s60, 0x3ffff
    s_waitcnt vmcnt(5)
    buffer_load_dwordx4 v[104:107], v1, s[8:11], s60 offen nt
    s_add_u32 s60, s60, 4096
    s_and_b32 s60, s60, 0x3ffff
    s_waitcnt vmcnt(5)
    buffer_load_dwordx4 v[108:111], v1, s[8:11], s60 offen nt
    s_add_u32 s60, s60, 4096
    s_and_b32 s60, s60, 0x3ffff
    s_waitcnt vmcnt(5)
    buffer_load_dwordx4 v[112:115], v1, s[8:11], s60 offen nt
    s_add_u32 s60, s60, 4096
    s_and_b32 s60, s60, 0x3ffff
    s_waitcnt vmcnt(5)
    buffer_load_dwordx4 v[116:119], v1, s[8:11], s60 offen nt
    s_add_u32 s60, s60, 4096
    s_and_b32 s60, s60, 0x3ffff
    s_waitcnt vmcnt(5)
    buffer_load_dwordx4 v[120:123], v1, s[8:11], s60 offen nt
    s_add_u32 s60, s60, 4096
    s_and_b32 s60, s60, 0x3ffff
    s_waitcnt vmcnt(5)
    buffer_load_dwordx4 v[124:127], v1, s[8:11], s60 offen nt
    s_add_u32 s60, s60, 4096
    s_and_b32 s60, s60, 0x3ffff
    s_waitcnt vmcnt(5)
    buffer_load_dwordx4 v[128:131], v1, s[8:11], s60 offen nt
    s_add_u32 s60, s60, 4096
    s_and_b32 s60, s60, 0x3ffff
    s_waitcnt vmcnt(5)
    buffer_load_dwordx4 v[132:135], v1, s[8:11], s60 offen nt
    s_add_u32 s60, s60, 4096
    s_and_b32 s60, s60, 0x3ffff
    s_waitcnt vmcnt(5)
    buffer_load_dwordx4 v[136:139], v1, s[8:11], s60 offen nt
    s_add_u32 s60, s60, 4096
    s_and_b32 s60, s60, 0x3ffff
    s_waitcnt vmcnt(5)
    buffer_load_dwordx4 v[140:143], v1, s[8:11], s60 offen nt
    s_add_u32 s60, s60, 4096
    s_and_b32 s60, s60, 0x3ffff
    s_waitcnt vmcnt(5)
    buffer_load_dwordx4 v[144:147], v1, s[8:11], s60 offen nt
    s_add_u32 s60, s60, 4096
    s_and_b32 s60, s60, 0x3ffff
    s_waitcnt vmcnt(5)
    buffer_load_dwordx4 v[148:151], v1, s[8:11], s60 offen nt
    s_add_u32 s60, s60, 4096
    s_and_b32 s60, s60, 0x3ffff
    s_waitcnt vmcnt(5)
    buffer_load_dwordx4 v[152:155], v1, s[8:11], s60 offen nt
    s_add_u32 s60, s60, 4096
    s_and_b32 s60, s60, 0x3ffff
    s_waitcnt vmcnt(5)
    buffer_load_dwordx4 v[156:159], v1, s[8:11], s60 offen nt
    s_add_u32 s60, s60, 4096
    s_and_b32 s60, s60, 0x3ffff
    s_waitcnt vmcnt(5)
    buffer_load_dwordx4 v[160:163], v1, s[8:11], s60 offen nt
    s_add_u32 s60, s60, 4096
    s_and_b32 s60, s60, 0x3ffff
    s_waitcnt vmcnt(5)
    buffer_load_dwordx4 v[164:167], v1, s[8:11], s60 offen nt
    s_add_u32 s60, s60, 4096
    s_and_b32 s60, s60, 0x3ffff
    s_waitcnt vmcnt(5)
    buffer_load_dwordx4 v[168:171], v1, s[8:11], s60 offen nt
    s_add_u32 s60, s60, 4096
    s_and_b32 s60, s60, 0x3ffff
    s_waitcnt vmcnt(5)
    buffer_load_dwordx4 v[172:175], v1, s[8:11], s60 offen nt
    s_add_u32 s60, s60, 4096
    s_and_b32 s60, s60, 0x3ffff
    s_waitcnt vmcnt(5)
    buffer_load_dwordx4 v[176:179], v1, s[8:11], s60 offen nt
    s_add_u32 s60, s60, 4096
    s_and_b32 s60, s60, 0x3ffff
    s_waitcnt vmcnt(5)
    buffer_load_dwordx4 v[180:183], v1, s[8:11], s60 offen nt
    s_add_u32 s60, s60, 4096
    s_and_b32 s60, s60, 0x3ffff
    s_waitcnt vmcnt(5)
    buffer_load_dwordx4 v[184:187], v1, s[8:11], s60 offen nt
    s_add_u32 s60, s60, 4096
    s_and_b32 s60, s60, 0x3ffff
    s_waitcnt vmcnt(5)
    buffer_load_dwordx4 v[188:191], v1, s[8:11], s60 offen nt
    s_add_u32 s60, s60, 4096
    s_and_b32 s60, s60, 0x3ffff
    s_waitcnt vmcnt(5)
    buffer_load_dwordx4 v[192:195], v1, s[8:11], s60 offen nt
    s_add_u32 s60, s60, 4096
    s_and_b32 s60, s60, 0x3ffff
    s_waitcnt vmcnt(5)
    buffer_load_dwordx4 v[196:199], v1, s[8:11], s60 offen nt
    s_add_u32 s60, s60, 4096
    s_and_b32 s60, s60, 0x3ffff
    s_waitcnt vmcnt(5)
    buffer_load_dwordx4 v[200:203], v1, s[8:11], s60 offen nt
    s_add_u32 s60, s60, 4096
    s_and_b32 s60, s60, 0x3ffff
    s_waitcnt vmcnt(5)
    buffer_load_dwordx4 v[204:207], v1, s[8:11], s60 offen nt
    s_add_u32 s60, s60, 4096
    s_and_b32 s60, s60, 0x3ffff
    s_waitcnt vmcnt(5)
    buffer_load_dwordx4 v[208:211], v1, s[8:11], s60 offen nt
    s_add_u32 s60, s60, 4096
    s_and_b32 s60, s60, 0x3ffff
    s_waitcnt vmcnt(5)
    buffer_load_dwordx4 v[212:215], v1, s[8:11], s60 offen nt
    s_add_u32 s60, s60, 4096
    s_and_b32 s60, s60, 0x3ffff
    s_waitcnt vmcnt(5)
    buffer_load_dwordx4 v[216:219], v1, s[8:11], s60 offen nt
    s_add_u32 s60, s60, 4096
    s_and_b32 s60, s60, 0x3ffff
    s_waitcnt vmcnt(5)
    buffer_load_dwordx4 v[220:223], v1, s[8:11], s60 offen nt
    s_add_u32 s60, s60, 4096
    s_and_b32 s60, s60, 0x3ffff
    s_waitcnt vmcnt(5)
    buffer_load_dwordx4 v[224:227], v1, s[8:11], s60 offen nt
    s_add_u32 s60, s60, 4096
    s_and_b32 s60, s60, 0x3ffff
    s_waitcnt vmcnt(5)
    buffer_load_dwordx4 v[228:231], v1, s[8:11], s60 offen nt
    s_add_u32 s60, s60, 4096
    s_and_b32 s60, s60, 0x3ffff
    s_waitcnt vmcnt(5)
    buffer_load_dwordx4 v[232:235], v1, s[8:11], s60 offen nt
    s_add_u32 s60, s60, 4096
    s_and_b32 s60, s60, 0x3ffff
    s_waitcnt vmcnt(5)
    buffer_load_dwordx4 v[236:239], v1, s[8:11], s60 offen nt
    s_add_u32 s60, s60, 4096
    s_and_b32 s60, s60, 0x3ffff
    s_waitcnt vmcnt(5)
    buffer_load_dwordx4 v[240:243], v1, s[8:11], s60 offen nt
    s_add_u32 s60, s60, 4096
    s_and_b32 s60, s60, 0x3ffff
    s_waitcnt vmcnt(5)
    buffer_load_dwordx4 v[244:247], v1, s[8:11], s60 offen nt
    s_add_u32 s60, s60, 4096
    s_and_b32 s60, s60, 0x3ffff
    s_waitcnt vmcnt(5)
    buffer_load_dwordx4 v[248:251], v1, s[8:11], s60 offen nt
    s_add_u32 s60, s60, 4096
    s_and_b32 s60, s60, 0x3ffff
    s_waitcnt vmcnt(5)
    buffer_load_dwordx4 v[252:255], v1, s[8:11], s60 offen nt
    s_add_u32 s60, s60, 4096
    s_and_b32 s60, s60, 0x3ffff
    v_mov_b32 v30, 0
    s_mov_b32 s63, 800000
L_wqs:
    ds_read_b32 v31, v30 offset:8
    s_waitcnt lgkmcnt(0)
    v_cmp_ne_u32 vcc, 4, v31
    s_cbranch_vccz L_wqs_done
    s_sub_u32 s63, s63, 1
    s_cbranch_scc0 L_wqs
L_wqs_done:
    ds_read_b128 v[2:5], v34 offset:64
    s_waitcnt lgkmcnt(0)
    v_dot2_f32_bf16 v6, v48, v2, 0
    v_dot2_f32_bf16 v7, v52, v2, 0
    v_dot2_f32_bf16 v8, v56, v2, 0
    v_dot2_f32_bf16 v9, v60, v2, 0
    v_dot2_f32_bf16 v6, v49, v3, v6
    v_dot2_f32_bf16 v7, v53, v3, v7
    v_dot2_f32_bf16 v8, v57, v3, v8
    v_dot2_f32_bf16 v9, v61, v3, v9
    v_dot2_f32_bf16 v6, v50, v4, v6
    v_dot2_f32_bf16 v7, v54, v4, v7
    v_dot2_f32_bf16 v8, v58, v4, v8
    v_dot2_f32_bf16 v9, v62, v4, v9
    v_dot2_f32_bf16 v6, v51, v5, v6
    v_dot2_f32_bf16 v7, v55, v5, v7
    v_dot2_f32_bf16 v8, v59, v5, v8
    v_dot2_f32_bf16 v9, v63, v5, v9
    v_add_f32_dpp v6, v6, v6 row_ror:8 row_mask:0xf bank_mask:0xf
    v_add_f32_dpp v7, v7, v7 row_ror:8 row_mask:0xf bank_mask:0xf
    v_add_f32_dpp v8, v8, v8 row_ror:8 row_mask:0xf bank_mask:0xf
    v_add_f32_dpp v9, v9, v9 row_ror:8 row_mask:0xf bank_mask:0xf
    s_waitcnt vmcnt(5)
    buffer_load_dwordx4 v[48:51], v1, s[8:11], s60 offen nt
    s_add_u32 s60, s60, 4096
    s_and_b32 s60, s60, 0x3ffff
    v_add_f32_dpp v6, v6, v6 row_ror:4 row_mask:0xf bank_mask:0xf
    v_add_f32_dpp v7, v7, v7 row_ror:4 row_mask:0xf bank_mask:0xf
    v_add_f32_dpp v8, v8, v8 row_ror:4 row_mask:0xf bank_mask:0xf
    v_add_f32_dpp v9, v9, v9 row_ror:4 row_mask:0xf bank_mask:0xf
    v_add_f32_dpp v6, v6, v6 row_ror:2 row_mask:0xf bank_mask:0xf
    v_add_f32_dpp v7, v7, v7 row_ror:2 row_mask:0xf bank_mask:0xf
    v_add_f32_dpp v8, v8, v8 row_ror:2 row_mask:0xf bank_mask:0xf
    v_add_f32_dpp v9, v9, v9 row_ror:2 row_mask:0xf bank_mask:0xf
    v_add_f32_dpp v6, v6, v6 row_ror:1 row_mask:0xf bank_mask:0xf
    v_add_f32_dpp v7, v7, v7 row_ror:1 row_mask:0xf bank_mask:0xf
    v_add_f32_dpp v8, v8, v8 row_ror:1 row_mask:0xf bank_mask:0xf
    v_add_f32_dpp v9, v9, v9 row_ror:1 row_mask:0xf bank_mask:0xf
    v_cndmask_b32 v10, v10, v6, s[64:65]
    s_lshl_b64 s[64:65], s[64:65], 1
    v_cndmask_b32 v10, v10, v7, s[64:65]
    s_lshl_b64 s[64:65], s[64:65], 1
    v_cndmask_b32 v10, v10, v8, s[64:65]
    s_lshl_b64 s[64:65], s[64:65], 1
    v_cndmask_b32 v10, v10, v9, s[64:65]
    s_lshl_b64 s[64:65], s[64:65], 1
    v_dot2_f32_bf16 v6, v64, v2, 0
    v_dot2_f32_bf16 v7, v68, v2, 0
    v_dot2_f32_bf16 v8, v72, v2, 0
    v_dot2_f32_bf16 v9, v76, v2, 0
    v_dot2_f32_bf16 v6, v65, v3, v6
    v_dot2_f32_bf16 v7, v69, v3, v7
    v_dot2_f32_bf16 v8, v73, v3, v8
    v_dot2_f32_bf16 v9, v77, v3, v9
    v_dot2_f32_bf16 v6, v66, v4, v6
    v_dot2_f32_bf16 v7, v70, v4, v7
    v_dot2_f32_bf16 v8, v74, v4, v8
    v_dot2_f32_bf16 v9, v78, v4, v9
    v_dot2_f32_bf16 v6, v67, v5, v6
    v_dot2_f32_bf16 v7, v71, v5, v7
    v_dot2_f32_bf16 v8, v75, v5, v8
    v_dot2_f32_bf16 v9, v79, v5, v9
    v_add_f32_dpp v6, v6, v6 row_ror:8 row_mask:0xf bank_mask:0xf
    v_add_f32_dpp v7, v7, v7 row_ror:8 row_mask:0xf bank_mask:0xf
    v_add_f32_dpp v8, v8, v8 row_ror:8 row_mask:0xf bank_mask:0xf
    v_add_f32_dpp v9, v9, v9 row_ror:8 row_mask:0xf bank_mask:0xf
    s_waitcnt vmcnt(5)
    buffer_load_dwordx4 v[52:55], v1, s[8:11], s60 offen nt
    s_add_u32 s60, s60, 4096
    s_and_b32 s60, s60, 0x3ffff
    v_add_f32_dpp v6, v6, v6 row_ror:4 row_mask:0xf bank_mask:0xf
    v_add_f32_dpp v7, v7, v7 row_ror:4 row_mask:0xf bank_mask:0xf
    v_add_f32_dpp v8, v8, v8 row_ror:4 row_mask:0xf bank_mask:0xf
    v_add_f32_dpp v9, v9, v9 row_ror:4 row_mask:0xf bank_mask:0xf
    v_add_f32_dpp v6, v6, v6 row_ror:2 row_mask:0xf bank_mask:0xf
    v_add_f32_dpp v7, v7, v7 row_ror:2 row_mask:0xf bank_mask:0xf
    v_add_f32_dpp v8, v8, v8 row_ror:2 row_mask:0xf bank_mask:0xf
    v_add_f32_dpp v9, v9, v9 row_ror:2 row_mask:0xf bank_mask:0xf
    v_add_f32_dpp v6, v6, v6 row_ror:1 row_mask:0xf bank_mask:0xf
    v_add_f32_dpp v7, v7, v7 row_ror:1 row_mask:0xf bank_mask:0xf
    v_add_f32_dpp v8, v8, v8 row_ror:1 row_mask:0xf bank_mask:0xf
    v_add_f32_dpp v9, v9, v9 row_ror:1 row_mask:0xf bank_mask:0xf
    v_cndmask_b32 v10, v10, v6, s[64:65]
    s_lshl_b64 s[64:65], s[64:65], 1
    v_cndmask_b32 v10, v10, v7, s[64:65]
    s_lshl_b64 s[64:65], s[64:65], 1
    v_cndmask_b32 v10, v10, v8, s[64:65]
    s_lshl_b64 s[64:65], s[64:65], 1
    v_cndmask_b32 v10, v10, v9, s[64:65]
    s_lshl_b64 s[64:65], s[64:65], 1
    v_dot2_f32_bf16 v6, v80, v2, 0
    v_dot2_f32_bf16 v7, v84, v2, 0
    v_dot2_f32_bf16 v8, v88, v2, 0
    v_dot2_f32_bf16 v9, v92, v2, 0
    v_dot2_f32_bf16 v6, v81, v3, v6
    v_dot2_f32_bf16 v7, v85, v3, v7
    v_dot2_f32_bf16 v8, v89, v3, v8
    v_dot2_f32_bf16 v9, v93, v3, v9
    v_dot2_f32_bf16 v6, v82, v4, v6
    v_dot2_f32_bf16 v7, v86, v4, v7
    v_dot2_f32_bf16 v8, v90, v4, v8
    v_dot2_f32_bf16 v9, v94, v4, v9
    v_dot2_f32_bf16 v6, v83, v5, v6
    v_dot2_f32_bf16 v7, v87, v5, v7
    v_dot2_f32_bf16 v8, v91, v5, v8
    v_dot2_f32_bf16 v9, v95, v5, v9
    v_add_f32_dpp v6, v6, v6 row_ror:8 row_mask:0xf bank_mask:0xf
    v_add_f32_dpp v7, v7, v7 row_ror:8 row_mask:0xf bank_mask:0xf
    v_add_f32_dpp v8, v8, v8 row_ror:8 row_mask:0xf bank_mask:0xf
    v_add_f32_dpp v9, v9, v9 row_ror:8 row_mask:0xf bank_mask:0xf
    s_waitcnt vmcnt(5)
    buffer_load_dwordx4 v[56:59], v1, s[8:11], s60 offen nt
    s_add_u32 s60, s60, 4096
    s_and_b32 s60, s60, 0x3ffff
    v_add_f32_dpp v6, v6, v6 row_ror:4 row_mask:0xf bank_mask:0xf
    v_add_f32_dpp v7, v7, v7 row_ror:4 row_mask:0xf bank_mask:0xf
    v_add_f32_dpp v8, v8, v8 row_ror:4 row_mask:0xf bank_mask:0xf
    v_add_f32_dpp v9, v9, v9 row_ror:4 row_mask:0xf bank_mask:0xf
    v_add_f32_dpp v6, v6, v6 row_ror:2 row_mask:0xf bank_mask:0xf
    v_add_f32_dpp v7, v7, v7 row_ror:2 row_mask:0xf bank_mask:0xf
    v_add_f32_dpp v8, v8, v8 row_ror:2 row_mask:0xf bank_mask:0xf
    v_add_f32_dpp v9, v9, v9 row_ror:2 row_mask:0xf bank_mask:0xf
    v_add_f32_dpp v6, v6, v6 row_ror:1 row_mask:0xf bank_mask:0xf
    v_add_f32_dpp v7, v7, v7 row_ror:1 row_mask:0xf bank_mask:0xf
    v_add_f32_dpp v8, v8, v8 row_ror:1 row_mask:0xf bank_mask:0xf
    v_add_f32_dpp v9, v9, v9 row_ror:1 row_mask:0xf bank_mask:0xf
    v_cndmask_b32 v10, v10, v6, s[64:65]
    s_lshl_b64 s[64:65], s[64:65], 1
    v_cndmask_b32 v10, v10, v7, s[64:65]
    s_lshl_b64 s[64:65], s[64:65], 1
    v_cndmask_b32 v10, v10, v8, s[64:65]
    s_lshl_b64 s[64:65], s[64:65], 1
    v_cndmask_b32 v10, v10, v9, s[64:65]
    s_lshl_b64 s[64:65], s[64:65], 1
    v_dot2_f32_bf16 v6, v96, v2, 0
    v_dot2_f32_bf16 v7, v100, v2, 0
    v_dot2_f32_bf16 v8, v104, v2, 0
    v_dot2_f32_bf16 v9, v108, v2, 0
    v_dot2_f32_bf16 v6, v97, v3, v6
    v_dot2_f32_bf16 v7, v101, v3, v7
    v_dot2_f32_bf16 v8, v105, v3, v8
    v_dot2_f32_bf16 v9, v109, v3, v9
    v_dot2_f32_bf16 v6, v98, v4, v6
    v_dot2_f32_bf16 v7, v102, v4, v7
    v_dot2_f32_bf16 v8, v106, v4, v8
    v_dot2_f32_bf16 v9, v110, v4, v9
    v_dot2_f32_bf16 v6, v99, v5, v6
    v_dot2_f32_bf16 v7, v103, v5, v7
    v_dot2_f32_bf16 v8, v107, v5, v8
    v_dot2_f32_bf16 v9, v111, v5, v9
    v_add_f32_dpp v6, v6, v6 row_ror:8 row_mask:0xf bank_mask:0xf
    v_add_f32_dpp v7, v7, v7 row_ror:8 row_mask:0xf bank_mask:0xf
    v_add_f32_dpp v8, v8, v8 row_ror:8 row_mask:0xf bank_mask:0xf
    v_add_f32_dpp v9, v9, v9 row_ror:8 row_mask:0xf bank_mask:0xf
    s_waitcnt vmcnt(5)
    buffer_load_dwordx4 v[60:63], v1, s[8:11], s60 offen nt
    s_add_u32 s60, s60, 4096
    s_and_b32 s60, s60, 0x3ffff
    v_add_f32_dpp v6, v6, v6 row_ror:4 row_mask:0xf bank_mask:0xf
    v_add_f32_dpp v7, v7, v7 row_ror:4 row_mask:0xf bank_mask:0xf
    v_add_f32_dpp v8, v8, v8 row_ror:4 row_mask:0xf bank_mask:0xf
    v_add_f32_dpp v9, v9, v9 row_ror:4 row_mask:0xf bank_mask:0xf
    v_add_f32_dpp v6, v6, v6 row_ror:2 row_mask:0xf bank_mask:0xf
    v_add_f32_dpp v7, v7, v7 row_ror:2 row_mask:0xf bank_mask:0xf
    v_add_f32_dpp v8, v8, v8 row_ror:2 row_mask:0xf bank_mask:0xf
    v_add_f32_dpp v9, v9, v9 row_ror:2 row_mask:0xf bank_mask:0xf
    v_add_f32_dpp v6, v6, v6 row_ror:1 row_mask:0xf bank_mask:0xf
    v_add_f32_dpp v7, v7, v7 row_ror:1 row_mask:0xf bank_mask:0xf
    v_add_f32_dpp v8, v8, v8 row_ror:1 row_mask:0xf bank_mask:0xf
    v_add_f32_dpp v9, v9, v9 row_ror:1 row_mask:0xf bank_mask:0xf
    v_cndmask_b32 v10, v10, v6, s[64:65]
    s_lshl_b64 s[64:65], s[64:65], 1
    v_cndmask_b32 v10, v10, v7, s[64:65]
    s_lshl_b64 s[64:65], s[64:65], 1
    v_cndmask_b32 v10, v10, v8, s[64:65]
    s_lshl_b64 s[64:65], s[64:65], 1
    v_cndmask_b32 v10, v10, v9, s[64:65]
    s_mov_b32 s64, 0x00010001
    s_mov_b32 s65, 0x00010001
    v_dot2_f32_bf16 v6, v112, v2, 0
    v_dot2_f32_bf16 v7, v116, v2, 0
    v_dot2_f32_bf16 v8, v120, v2, 0
    v_dot2_f32_bf16 v9, v124, v2, 0
    v_dot2_f32_bf16 v6, v113, v3, v6
    v_dot2_f32_bf16 v7, v117, v3, v7
    v_dot2_f32_bf16 v8, v121, v3, v8
    v_dot2_f32_bf16 v9, v125, v3, v9
    v_dot2_f32_bf16 v6, v114, v4, v6
    v_dot2_f32_bf16 v7, v118, v4, v7
    v_dot2_f32_bf16 v8, v122, v4, v8
    v_dot2_f32_bf16 v9, v126, v4, v9
    v_dot2_f32_bf16 v6, v115, v5, v6
    v_dot2_f32_bf16 v7, v119, v5, v7
    v_dot2_f32_bf16 v8, v123, v5, v8
    v_dot2_f32_bf16 v9, v127, v5, v9
    v_add_f32_dpp v6, v6, v6 row_ror:8 row_mask:0xf bank_mask:0xf
    v_add_f32_dpp v7, v7, v7 row_ror:8 row_mask:0xf bank_mask:0xf
    v_add_f32_dpp v8, v8, v8 row_ror:8 row_mask:0xf bank_mask:0xf
    v_add_f32_dpp v9, v9, v9 row_ror:8 row_mask:0xf bank_mask:0xf
    s_waitcnt vmcnt(5)
    buffer_load_dwordx4 v[64:67], v1, s[8:11], s60 offen nt
    s_add_u32 s60, s60, 4096
    s_and_b32 s60, s60, 0x3ffff
    v_add_f32_dpp v6, v6, v6 row_ror:4 row_mask:0xf bank_mask:0xf
    v_add_f32_dpp v7, v7, v7 row_ror:4 row_mask:0xf bank_mask:0xf
    v_add_f32_dpp v8, v8, v8 row_ror:4 row_mask:0xf bank_mask:0xf
    v_add_f32_dpp v9, v9, v9 row_ror:4 row_mask:0xf bank_mask:0xf
    v_add_f32_dpp v6, v6, v6 row_ror:2 row_mask:0xf bank_mask:0xf
    v_add_f32_dpp v7, v7, v7 row_ror:2 row_mask:0xf bank_mask:0xf
    v_add_f32_dpp v8, v8, v8 row_ror:2 row_mask:0xf bank_mask:0xf
    v_add_f32_dpp v9, v9, v9 row_ror:2 row_mask:0xf bank_mask:0xf
    v_add_f32_dpp v6, v6, v6 row_ror:1 row_mask:0xf bank_mask:0xf
    v_add_f32_dpp v7, v7, v7 row_ror:1 row_mask:0xf bank_mask:0xf
    v_add_f32_dpp v8, v8, v8 row_ror:1 row_mask:0xf bank_mask:0xf
    v_add_f32_dpp v9, v9, v9 row_ror:1 row_mask:0xf bank_mask:0xf
    v_cndmask_b32 v11, v11, v6, s[64:65]
    s_lshl_b64 s[64:65], s[64:65], 1
    v_cndmask_b32 v11, v11, v7, s[64:65]
    s_lshl_b64 s[64:65], s[64:65], 1
    v_cndmask_b32 v11, v11, v8, s[64:65]
    s_lshl_b64 s[64:65], s[64:65], 1
    v_cndmask_b32 v11, v11, v9, s[64:65]
    s_lshl_b64 s[64:65], s[64:65], 1
    v_dot2_f32_bf16 v6, v128, v2, 0
    v_dot2_f32_bf16 v7, v132, v2, 0
    v_dot2_f32_bf16 v8, v136, v2, 0
    v_dot2_f32_bf16 v9, v140, v2, 0
    v_dot2_f32_bf16 v6, v129, v3, v6
    v_dot2_f32_bf16 v7, v133, v3, v7
    v_dot2_f32_bf16 v8, v137, v3, v8
    v_dot2_f32_bf16 v9, v141, v3, v9
    v_dot2_f32_bf16 v6, v130, v4, v6
    v_dot2_f32_bf16 v7, v134, v4, v7
    v_dot2_f32_bf16 v8, v138, v4, v8
    v_dot2_f32_bf16 v9, v142, v4, v9
    v_dot2_f32_bf16 v6, v131, v5, v6
    v_dot2_f32_bf16 v7, v135, v5, v7
    v_dot2_f32_bf16 v8, v139, v5, v8
    v_dot2_f32_bf16 v9, v143, v5, v9
    v_add_f32_dpp v6, v6, v6 row_ror:8 row_mask:0xf bank_mask:0xf
    v_add_f32_dpp v7, v7, v7 row_ror:8 row_mask:0xf bank_mask:0xf
    v_add_f32_dpp v8, v8, v8 row_ror:8 row_mask:0xf bank_mask:0xf
    v_add_f32_dpp v9, v9, v9 row_ror:8 row_mask:0xf bank_mask:0xf
    s_waitcnt vmcnt(5)
    buffer_load_dwordx4 v[68:71], v1, s[8:11], s60 offen nt
    s_add_u32 s60, s60, 4096
    s_and_b32 s60, s60, 0x3ffff
    v_add_f32_dpp v6, v6, v6 row_ror:4 row_mask:0xf bank_mask:0xf
    v_add_f32_dpp v7, v7, v7 row_ror:4 row_mask:0xf bank_mask:0xf
    v_add_f32_dpp v8, v8, v8 row_ror:4 row_mask:0xf bank_mask:0xf
    v_add_f32_dpp v9, v9, v9 row_ror:4 row_mask:0xf bank_mask:0xf
    v_add_f32_dpp v6, v6, v6 row_ror:2 row_mask:0xf bank_mask:0xf
    v_add_f32_dpp v7, v7, v7 row_ror:2 row_mask:0xf bank_mask:0xf
    v_add_f32_dpp v8, v8, v8 row_ror:2 row_mask:0xf bank_mask:0xf
    v_add_f32_dpp v9, v9, v9 row_ror:2 row_mask:0xf bank_mask:0xf
    v_add_f32_dpp v6, v6, v6 row_ror:1 row_mask:0xf bank_mask:0xf
    v_add_f32_dpp v7, v7, v7 row_ror:1 row_mask:0xf bank_mask:0xf
    v_add_f32_dpp v8, v8, v8 row_ror:1 row_mask:0xf bank_mask:0xf
    v_add_f32_dpp v9, v9, v9 row_ror:1 row_mask:0xf bank_mask:0xf
    v_cndmask_b32 v11, v11, v6, s[64:65]
    s_lshl_b64 s[64:65], s[64:65], 1
    v_cndmask_b32 v11, v11, v7, s[64:65]
    s_lshl_b64 s[64:65], s[64:65], 1
    v_cndmask_b32 v11, v11, v8, s[64:65]
    s_lshl_b64 s[64:65], s[64:65], 1
    v_cndmask_b32 v11, v11, v9, s[64:65]
    s_lshl_b64 s[64:65], s[64:65], 1
    v_dot2_f32_bf16 v6, v144, v2, 0
    v_dot2_f32_bf16 v7, v148, v2, 0
    v_dot2_f32_bf16 v8, v152, v2, 0
    v_dot2_f32_bf16 v9, v156, v2, 0
    v_dot2_f32_bf16 v6, v145, v3, v6
    v_dot2_f32_bf16 v7, v149, v3, v7
    v_dot2_f32_bf16 v8, v153, v3, v8
    v_dot2_f32_bf16 v9, v157, v3, v9
    v_dot2_f32_bf16 v6, v146, v4, v6
    v_dot2_f32_bf16 v7, v150, v4, v7
    v_dot2_f32_bf16 v8, v154, v4, v8
    v_dot2_f32_bf16 v9, v158, v4, v9
    v_dot2_f32_bf16 v6, v147, v5, v6
    v_dot2_f32_bf16 v7, v151, v5, v7
    v_dot2_f32_bf16 v8, v155, v5, v8
    v_dot2_f32_bf16 v9, v159, v5, v9
    v_add_f32_dpp v6, v6, v6 row_ror:8 row_mask:0xf bank_mask:0xf
    v_add_f32_dpp v7, v7, v7 row_ror:8 row_mask:0xf bank_mask:0xf
    v_add_f32_dpp v8, v8, v8 row_ror:8 row_mask:0xf bank_mask:0xf
    v_add_f32_dpp v9, v9, v9 row_ror:8 row_mask:0xf bank_mask:0xf
    s_waitcnt vmcnt(5)
    buffer_load_dwordx4 v[72:75], v1, s[8:11], s60 offen nt
    s_add_u32 s60, s60, 4096
    s_and_b32 s60, s60, 0x3ffff
    v_add_f32_dpp v6, v6, v6 row_ror:4 row_mask:0xf bank_mask:0xf
    v_add_f32_dpp v7, v7, v7 row_ror:4 row_mask:0xf bank_mask:0xf
    v_add_f32_dpp v8, v8, v8 row_ror:4 row_mask:0xf bank_mask:0xf
    v_add_f32_dpp v9, v9, v9 row_ror:4 row_mask:0xf bank_mask:0xf
    v_add_f32_dpp v6, v6, v6 row_ror:2 row_mask:0xf bank_mask:0xf
    v_add_f32_dpp v7, v7, v7 row_ror:2 row_mask:0xf bank_mask:0xf
    v_add_f32_dpp v8, v8, v8 row_ror:2 row_mask:0xf bank_mask:0xf
    v_add_f32_dpp v9, v9, v9 row_ror:2 row_mask:0xf bank_mask:0xf
    v_add_f32_dpp v6, v6, v6 row_ror:1 row_mask:0xf bank_mask:0xf
    v_add_f32_dpp v7, v7, v7 row_ror:1 row_mask:0xf bank_mask:0xf
    v_add_f32_dpp v8, v8, v8 row_ror:1 row_mask:0xf bank_mask:0xf
    v_add_f32_dpp v9, v9, v9 row_ror:1 row_mask:0xf bank_mask:0xf
    v_cndmask_b32 v11, v11, v6, s[64:65]
    s_lshl_b64 s[64:65], s[64:65], 1
    v_cndmask_b32 v11, v11, v7, s[64:65]
    s_lshl_b64 s[64:65], s[64:65], 1
    v_cndmask_b32 v11, v11, v8, s[64:65]
    s_lshl_b64 s[64:65], s[64:65], 1
    v_cndmask_b32 v11, v11, v9, s[64:65]
    s_lshl_b64 s[64:65], s[64:65], 1
    v_dot2_f32_bf16 v6, v160, v2, 0
    v_dot2_f32_bf16 v7, v164, v2, 0
    v_dot2_f32_bf16 v8, v168, v2, 0
    v_dot2_f32_bf16 v9, v172, v2, 0
    v_dot2_f32_bf16 v6, v161, v3, v6
    v_dot2_f32_bf16 v7, v165, v3, v7
    v_dot2_f32_bf16 v8, v169, v3, v8
    v_dot2_f32_bf16 v9, v173, v3, v9
    v_dot2_f32_bf16 v6, v162, v4, v6
    v_dot2_f32_bf16 v7, v166, v4, v7
    v_dot2_f32_bf16 v8, v170, v4, v8
    v_dot2_f32_bf16 v9, v174, v4, v9
    v_dot2_f32_bf16 v6, v163, v5, v6
    v_dot2_f32_bf16 v7, v167, v5, v7
    v_dot2_f32_bf16 v8, v171, v5, v8
    v_dot2_f32_bf16 v9, v175, v5, v9
    v_add_f32_dpp v6, v6, v6 row_ror:8 row_mask:0xf bank_mask:0xf
    v_add_f32_dpp v7, v7, v7 row_ror:8 row_mask:0xf bank_mask:0xf
    v_add_f32_dpp v8, v8, v8 row_ror:8 row_mask:0xf bank_mask:0xf
    v_add_f32_dpp v9, v9, v9 row_ror:8 row_mask:0xf bank_mask:0xf
    s_waitcnt vmcnt(5)
    buffer_load_dwordx4 v[76:79], v1, s[8:11], s60 offen nt
    s_add_u32 s60, s60, 4096
    s_and_b32 s60, s60, 0x3ffff
    v_add_f32_dpp v6, v6, v6 row_ror:4 row_mask:0xf bank_mask:0xf
    v_add_f32_dpp v7, v7, v7 row_ror:4 row_mask:0xf bank_mask:0xf
    v_add_f32_dpp v8, v8, v8 row_ror:4 row_mask:0xf bank_mask:0xf
    v_add_f32_dpp v9, v9, v9 row_ror:4 row_mask:0xf bank_mask:0xf
    v_add_f32_dpp v6, v6, v6 row_ror:2 row_mask:0xf bank_mask:0xf
    v_add_f32_dpp v7, v7, v7 row_ror:2 row_mask:0xf bank_mask:0xf
    v_add_f32_dpp v8, v8, v8 row_ror:2 row_mask:0xf bank_mask:0xf
    v_add_f32_dpp v9, v9, v9 row_ror:2 row_mask:0xf bank_mask:0xf
    v_add_f32_dpp v6, v6, v6 row_ror:1 row_mask:0xf bank_mask:0xf
    v_add_f32_dpp v7, v7, v7 row_ror:1 row_mask:0xf bank_mask:0xf
    v_add_f32_dpp v8, v8, v8 row_ror:1 row_mask:0xf bank_mask:0xf
    v_add_f32_dpp v9, v9, v9 row_ror:1 row_mask:0xf bank_mask:0xf
    v_cndmask_b32 v11, v11, v6, s[64:65]
    s_lshl_b64 s[64:65], s[64:65], 1
    v_cndmask_b32 v11, v11, v7, s[64:65]
    s_lshl_b64 s[64:65], s[64:65], 1
    v_cndmask_b32 v11, v11, v8, s[64:65]
    s_lshl_b64 s[64:65], s[64:65], 1
    v_cndmask_b32 v11, v11, v9, s[64:65]
    s_mov_b32 s64, 0x00010001
    s_mov_b32 s65, 0x00010001
    v_dot2_f32_bf16 v6, v176, v2, 0
    v_dot2_f32_bf16 v7, v180, v2, 0
    v_dot2_f32_bf16 v8, v184, v2, 0
    v_dot2_f32_bf16 v9, v188, v2, 0
    v_dot2_f32_bf16 v6, v177, v3, v6
    v_dot2_f32_bf16 v7, v181, v3, v7
    v_dot2_f32_bf16 v8, v185, v3, v8
    v_dot2_f32_bf16 v9, v189, v3, v9
    v_dot2_f32_bf16 v6, v178, v4, v6
    v_dot2_f32_bf16 v7, v182, v4, v7
    v_dot2_f32_bf16 v8, v186, v4, v8
    v_dot2_f32_bf16 v9, v190, v4, v9
    v_dot2_f32_bf16 v6, v179, v5, v6
    v_dot2_f32_bf16 v7, v183, v5, v7
    v_dot2_f32_bf16 v8, v187, v5, v8
    v_dot2_f32_bf16 v9, v191, v5, v9
    v_add_f32_dpp v6, v6, v6 row_ror:8 row_mask:0xf bank_mask:0xf
    v_add_f32_dpp v7, v7, v7 row_ror:8 row_mask:0xf bank_mask:0xf
    v_add_f32_dpp v8, v8, v8 row_ror:8 row_mask:0xf bank_mask:0xf
    v_add_f32_dpp v9, v9, v9 row_ror:8 row_mask:0xf bank_mask:0xf
    s_waitcnt vmcnt(5)
    buffer_load_dwordx4 v[80:83], v1, s[8:11], s60 offen nt
    s_add_u32 s60, s60, 4096
    s_and_b32 s60, s60, 0x3ffff
    v_add_f32_dpp v6, v6, v6 row_ror:4 row_mask:0xf bank_mask:0xf
    v_add_f32_dpp v7, v7, v7 row_ror:4 row_mask:0xf bank_mask:0xf
    v_add_f32_dpp v8, v8, v8 row_ror:4 row_mask:0xf bank_mask:0xf
    v_add_f32_dpp v9, v9, v9 row_ror:4 row_mask:0xf bank_mask:0xf
    v_add_f32_dpp v6, v6, v6 row_ror:2 row_mask:0xf bank_mask:0xf
    v_add_f32_dpp v7, v7, v7 row_ror:2 row_mask:0xf bank_mask:0xf
    v_add_f32_dpp v8, v8, v8 row_ror:2 row_mask:0xf bank_mask:0xf
    v_add_f32_dpp v9, v9, v9 row_ror:2 row_mask:0xf bank_mask:0xf
    v_add_f32_dpp v6, v6, v6 row_ror:1 row_mask:0xf bank_mask:0xf
    v_add_f32_dpp v7, v7, v7 row_ror:1 row_mask:0xf bank_mask:0xf
    v_add_f32_dpp v8, v8, v8 row_ror:1 row_mask:0xf bank_mask:0xf
    v_add_f32_dpp v9, v9, v9 row_ror:1 row_mask:0xf bank_mask:0xf
    v_cndmask_b32 v12, v12, v6, s[64:65]
    s_lshl_b64 s[64:65], s[64:65], 1
    v_cndmask_b32 v12, v12, v7, s[64:65]
    s_lshl_b64 s[64:65], s[64:65], 1
    v_cndmask_b32 v12, v12, v8, s[64:65]
    s_lshl_b64 s[64:65], s[64:65], 1
    v_cndmask_b32 v12, v12, v9, s[64:65]
    s_lshl_b64 s[64:65], s[64:65], 1
    v_dot2_f32_bf16 v6, v192, v2, 0
    v_dot2_f32_bf16 v7, v196, v2, 0
    v_dot2_f32_bf16 v8, v200, v2, 0
    v_dot2_f32_bf16 v9, v204, v2, 0
    v_dot2_f32_bf16 v6, v193, v3, v6
    v_dot2_f32_bf16 v7, v197, v3, v7
    v_dot2_f32_bf16 v8, v201, v3, v8
    v_dot2_f32_bf16 v9, v205, v3, v9
    v_dot2_f32_bf16 v6, v194, v4, v6
    v_dot2_f32_bf16 v7, v198, v4, v7
    v_dot2_f32_bf16 v8, v202, v4, v8
    v_dot2_f32_bf16 v9, v206, v4, v9
    v_dot2_f32_bf16 v6, v195, v5, v6
    v_dot2_f32_bf16 v7, v199, v5, v7
    v_dot2_f32_bf16 v8, v203, v5, v8
    v_dot2_f32_bf16 v9, v207, v5, v9
    v_add_f32_dpp v6, v6, v6 row_ror:8 row_mask:0xf bank_mask:0xf
    v_add_f32_dpp v7, v7, v7 row_ror:8 row_mask:0xf bank_mask:0xf
    v_add_f32_dpp v8, v8, v8 row_ror:8 row_mask:0xf bank_mask:0xf
    v_add_f32_dpp v9, v9, v9 row_ror:8 row_mask:0xf bank_mask:0xf
    s_waitcnt vmcnt(5)
    buffer_load_dwordx4 v[84:87], v1, s[8:11], s60 offen nt
    s_add_u32 s60, s60, 4096
    s_and_b32 s60, s60, 0x3ffff
    v_add_f32_dpp v6, v6, v6 row_ror:4 row_mask:0xf bank_mask:0xf
    v_add_f32_dpp v7, v7, v7 row_ror:4 row_mask:0xf bank_mask:0xf
    v_add_f32_dpp v8, v8, v8 row_ror:4 row_mask:0xf bank_mask:0xf
    v_add_f32_dpp v9, v9, v9 row_ror:4 row_mask:0xf bank_mask:0xf
    v_add_f32_dpp v6, v6, v6 row_ror:2 row_mask:0xf bank_mask:0xf
    v_add_f32_dpp v7, v7, v7 row_ror:2 row_mask:0xf bank_mask:0xf
    v_add_f32_dpp v8, v8, v8 row_ror:2 row_mask:0xf bank_mask:0xf
    v_add_f32_dpp v9, v9, v9 row_ror:2 row_mask:0xf bank_mask:0xf
    v_add_f32_dpp v6, v6, v6 row_ror:1 row_mask:0xf bank_mask:0xf
    v_add_f32_dpp v7, v7, v7 row_ror:1 row_mask:0xf bank_mask:0xf
    v_add_f32_dpp v8, v8, v8 row_ror:1 row_mask:0xf bank_mask:0xf
    v_add_f32_dpp v9, v9, v9 row_ror:1 row_mask:0xf bank_mask:0xf
    v_cndmask_b32 v12, v12, v6, s[64:65]
    s_lshl_b64 s[64:65], s[64:65], 1
    v_cndmask_b32 v12, v12, v7, s[64:65]
    s_lshl_b64 s[64:65], s[64:65], 1
    v_cndmask_b32 v12, v12, v8, s[64:65]
    s_lshl_b64 s[64:65], s[64:65], 1
    v_cndmask_b32 v12, v12, v9, s[64:65]
    s_lshl_b64 s[64:65], s[64:65], 1
    v_dot2_f32_bf16 v6, v208, v2, 0
    v_dot2_f32_bf16 v7, v212, v2, 0
    v_dot2_f32_bf16 v8, v216, v2, 0
    v_dot2_f32_bf16 v9, v220, v2, 0
    v_dot2_f32_bf16 v6, v209, v3, v6
    v_dot2_f32_bf16 v7, v213, v3, v7
    v_dot2_f32_bf16 v8, v217, v3, v8
    v_dot2_f32_bf16 v9, v221, v3, v9
    v_dot2_f32_bf16 v6, v210, v4, v6
    v_dot2_f32_bf16 v7, v214, v4, v7
    v_dot2_f32_bf16 v8, v218, v4, v8
    v_dot2_f32_bf16 v9, v222, v4, v9
    v_dot2_f32_bf16 v6, v211, v5, v6
    v_dot2_f32_bf16 v7, v215, v5, v7
    v_dot2_f32_bf16 v8, v219, v5, v8
    v_dot2_f32_bf16 v9, v223, v5, v9
    v_add_f32_dpp v6, v6, v6 row_ror:8 row_mask:0xf bank_mask:0xf
    v_add_f32_dpp v7, v7, v7 row_ror:8 row_mask:0xf bank_mask:0xf
    v_add_f32_dpp v8, v8, v8 row_ror:8 row_mask:0xf bank_mask:0xf
    v_add_f32_dpp v9, v9, v9 row_ror:8 row_mask:0xf bank_mask:0xf
    s_waitcnt vmcnt(5)
    buffer_load_dwordx4 v[88:91], v1, s[8:11], s60 offen nt
    s_add_u32 s60, s60, 4096
    s_and_b32 s60, s60, 0x3ffff
    v_add_f32_dpp v6, v6, v6 row_ror:4 row_mask:0xf bank_mask:0xf
    v_add_f32_dpp v7, v7, v7 row_ror:4 row_mask:0xf bank_mask:0xf
    v_add_f32_dpp v8, v8, v8 row_ror:4 row_mask:0xf bank_mask:0xf
    v_add_f32_dpp v9, v9, v9 row_ror:4 row_mask:0xf bank_mask:0xf
    v_add_f32_dpp v6, v6, v6 row_ror:2 row_mask:0xf bank_mask:0xf
    v_add_f32_dpp v7, v7, v7 row_ror:2 row_mask:0xf bank_mask:0xf
    v_add_f32_dpp v8, v8, v8 row_ror:2 row_mask:0xf bank_mask:0xf
    v_add_f32_dpp v9, v9, v9 row_ror:2 row_mask:0xf bank_mask:0xf
    v_add_f32_dpp v6, v6, v6 row_ror:1 row_mask:0xf bank_mask:0xf
    v_add_f32_dpp v7, v7, v7 row_ror:1 row_mask:0xf bank_mask:0xf
    v_add_f32_dpp v8, v8, v8 row_ror:1 row_mask:0xf bank_mask:0xf
    v_add_f32_dpp v9, v9, v9 row_ror:1 row_mask:0xf bank_mask:0xf
    v_cndmask_b32 v12, v12, v6, s[64:65]
    s_lshl_b64 s[64:65], s[64:65], 1
    v_cndmask_b32 v12, v12, v7, s[64:65]
    s_lshl_b64 s[64:65], s[64:65], 1
    v_cndmask_b32 v12, v12, v8, s[64:65]
    s_lshl_b64 s[64:65], s[64:65], 1
    v_cndmask_b32 v12, v12, v9, s[64:65]
    s_lshl_b64 s[64:65], s[64:65], 1
    v_dot2_f32_bf16 v6, v224, v2, 0
    v_dot2_f32_bf16 v7, v228, v2, 0
    v_dot2_f32_bf16 v8, v232, v2, 0
    v_dot2_f32_bf16 v9, v236, v2, 0
    v_dot2_f32_bf16 v6, v225, v3, v6
    v_dot2_f32_bf16 v7, v229, v3, v7
    v_dot2_f32_bf16 v8, v233, v3, v8
    v_dot2_f32_bf16 v9, v237, v3, v9
    v_dot2_f32_bf16 v6, v226, v4, v6
    v_dot2_f32_bf16 v7, v230, v4, v7
    v_dot2_f32_bf16 v8, v234, v4, v8
    v_dot2_f32_bf16 v9, v238, v4, v9
    v_dot2_f32_bf16 v6, v227, v5, v6
    v_dot2_f32_bf16 v7, v231, v5, v7
    v_dot2_f32_bf16 v8, v235, v5, v8
    v_dot2_f32_bf16 v9, v239, v5, v9
    v_add_f32_dpp v6, v6, v6 row_ror:8 row_mask:0xf bank_mask:0xf
    v_add_f32_dpp v7, v7, v7 row_ror:8 row_mask:0xf bank_mask:0xf
    v_add_f32_dpp v8, v8, v8 row_ror:8 row_mask:0xf bank_mask:0xf
    v_add_f32_dpp v9, v9, v9 row_ror:8 row_mask:0xf bank_mask:0xf
    s_waitcnt vmcnt(5)
    buffer_load_dwordx4 v[92:95], v1, s[8:11], s60 offen nt
    s_add_u32 s60, s60, 4096
    s_and_b32 s60, s60, 0x3ffff
    v_add_f32_dpp v6, v6, v6 row_ror:4 row_mask:0xf bank_mask:0xf
    v_add_f32_dpp v7, v7, v7 row_ror:4 row_mask:0xf bank_mask:0xf
    v_add_f32_dpp v8, v8, v8 row_ror:4 row_mask:0xf bank_mask:0xf
    v_add_f32_dpp v9, v9, v9 row_ror:4 row_mask:0xf bank_mask:0xf
    v_add_f32_dpp v6, v6, v6 row_ror:2 row_mask:0xf bank_mask:0xf
    v_add_f32_dpp v7, v7, v7 row_ror:2 row_mask:0xf bank_mask:0xf
    v_add_f32_dpp v8, v8, v8 row_ror:2 row_mask:0xf bank_mask:0xf
    v_add_f32_dpp v9, v9, v9 row_ror:2 row_mask:0xf bank_mask:0xf
    v_add_f32_dpp v6, v6, v6 row_ror:1 row_mask:0xf bank_mask:0xf
    v_add_f32_dpp v7, v7, v7 row_ror:1 row_mask:0xf bank_mask:0xf
    v_add_f32_dpp v8, v8, v8 row_ror:1 row_mask:0xf bank_mask:0xf
    v_add_f32_dpp v9, v9, v9 row_ror:1 row_mask:0xf bank_mask:0xf
    v_cndmask_b32 v12, v12, v6, s[64:65]
    s_lshl_b64 s[64:65], s[64:65], 1
    v_cndmask_b32 v12, v12, v7, s[64:65]
    s_lshl_b64 s[64:65], s[64:65], 1
    v_cndmask_b32 v12, v12, v8, s[64:65]
    s_lshl_b64 s[64:65], s[64:65], 1
    v_cndmask_b32 v12, v12, v9, s[64:65]
    s_mov_b32 s64, 0x00010001
    s_mov_b32 s65, 0x00010001
    v_dot2_f32_bf16 v6, v240, v2, 0
    v_dot2_f32_bf16 v7, v244, v2, 0
    v_dot2_f32_bf16 v8, v248, v2, 0
    v_dot2_f32_bf16 v9, v252, v2, 0
    v_dot2_f32_bf16 v6, v241, v3, v6
    v_dot2_f32_bf16 v7, v245, v3, v7
    v_dot2_f32_bf16 v8, v249, v3, v8
    v_dot2_f32_bf16 v9, v253, v3, v9
    v_dot2_f32_bf16 v6, v242, v4, v6
    v_dot2_f32_bf16 v7, v246, v4, v7
    v_dot2_f32_bf16 v8, v250, v4, v8
    v_dot2_f32_bf16 v9, v254, v4, v9
    v_dot2_f32_bf16 v6, v243, v5, v6
    v_dot2_f32_bf16 v7, v247, v5, v7
    v_dot2_f32_bf16 v8, v251, v5, v8
    v_dot2_f32_bf16 v9, v255, v5, v9
    v_add_f32_dpp v6, v6, v6 row_ror:8 row_mask:0xf bank_mask:0xf
    v_add_f32_dpp v7, v7, v7 row_ror:8 row_mask:0xf bank_mask:0xf
    v_add_f32_dpp v8, v8, v8 row_ror:8 row_mask:0xf bank_mask:0xf
    v_add_f32_dpp v9, v9, v9 row_ror:8 row_mask:0xf bank_mask:0xf
    s_waitcnt vmcnt(5)
    buffer_load_dwordx4 v[96:99], v1, s[12:15], s60 offen nt
    s_add_u32 s60, s60, 4096
    s_and_b32 s60, s60, 0x3ffff
    v_add_f32_dpp v6, v6, v6 row_ror:4 row_mask:0xf bank_mask:0xf
    v_add_f32_dpp v7, v7, v7 row_ror:4 row_mask:0xf bank_mask:0xf
    v_add_f32_dpp v8, v8, v8 row_ror:4 row_mask:0xf bank_mask:0xf
    v_add_f32_dpp v9, v9, v9 row_ror:4 row_mask:0xf bank_mask:0xf
    v_add_f32_dpp v6, v6, v6 row_ror:2 row_mask:0xf bank_mask:0xf
    v_add_f32_dpp v7, v7, v7 row_ror:2 row_mask:0xf bank_mask:0xf
    v_add_f32_dpp v8, v8, v8 row_ror:2 row_mask:0xf bank_mask:0xf
    v_add_f32_dpp v9, v9, v9 row_ror:2 row_mask:0xf bank_mask:0xf
    v_add_f32_dpp v6, v6, v6 row_ror:1 row_mask:0xf bank_mask:0xf
    v_add_f32_dpp v7, v7, v7 row_ror:1 row_mask:0xf bank_mask:0xf
    v_add_f32_dpp v8, v8, v8 row_ror:1 row_mask:0xf bank_mask:0xf
    v_add_f32_dpp v9, v9, v9 row_ror:1 row_mask:0xf bank_mask:0xf
    v_cndmask_b32 v13, v13, v6, s[64:65]
    s_lshl_b64 s[64:65], s[64:65], 1
    v_cndmask_b32 v13, v13, v7, s[64:65]
    s_lshl_b64 s[64:65], s[64:65], 1
    v_cndmask_b32 v13, v13, v8, s[64:65]
    s_lshl_b64 s[64:65], s[64:65], 1
    v_cndmask_b32 v13, v13, v9, s[64:65]
    s_lshl_b64 s[64:65], s[64:65], 1
    v_dot2_f32_bf16 v6, v48, v2, 0
    v_dot2_f32_bf16 v7, v52, v2, 0
    v_dot2_f32_bf16 v8, v56, v2, 0
    v_dot2_f32_bf16 v9, v60, v2, 0
    v_dot2_f32_bf16 v6, v49, v3, v6
    v_dot2_f32_bf16 v7, v53, v3, v7
    v_dot2_f32_bf16 v8, v57, v3, v8
    v_dot2_f32_bf16 v9, v61, v3, v9
    v_dot2_f32_bf16 v6, v50, v4, v6
    v_dot2_f32_bf16 v7, v54, v4, v7
    v_dot2_f32_bf16 v8, v58, v4, v8
    v_dot2_f32_bf16 v9, v62, v4, v9
    v_dot2_f32_bf16 v6, v51, v5, v6
    v_dot2_f32_bf16 v7, v55, v5, v7
    v_dot2_f32_bf16 v8, v59, v5, v8
    v_dot2_f32_bf16 v9, v63, v5, v9
    v_add_f32_dpp v6, v6, v6 row_ror:8 row_mask:0xf bank_mask:0xf
    v_add_f32_dpp v7, v7, v7 row_ror:8 row_mask:0xf bank_mask:0xf
    v_add_f32_dpp v8, v8, v8 row_ror:8 row_mask:0xf bank_mask:0xf
    v_add_f32_dpp v9, v9, v9 row_ror:8 row_mask:0xf bank_mask:0xf
    s_waitcnt vmcnt(5)
    buffer_load_dwordx4 v[100:103], v1, s[12:15], s60 offen nt
    s_add_u32 s60, s60, 4096
    s_and_b32 s60, s60, 0x3ffff
    v_add_f32_dpp v6, v6, v6 row_ror:4 row_mask:0xf bank_mask:0xf
    v_add_f32_dpp v7, v7, v7 row_ror:4 row_mask:0xf bank_mask:0xf
    v_add_f32_dpp v8, v8, v8 row_ror:4 row_mask:0xf bank_mask:0xf
    v_add_f32_dpp v9, v9, v9 row_ror:4 row_mask:0xf bank_mask:0xf
    v_add_f32_dpp v6, v6, v6 row_ror:2 row_mask:0xf bank_mask:0xf
    v_add_f32_dpp v7, v7, v7 row_ror:2 row_mask:0xf bank_mask:0xf
    v_add_f32_dpp v8, v8, v8 row_ror:2 row_mask:0xf bank_mask:0xf
    v_add_f32_dpp v9, v9, v9 row_ror:2 row_mask:0xf bank_mask:0xf
    v_add_f32_dpp v6, v6, v6 row_ror:1 row_mask:0xf bank_mask:0xf
    v_add_f32_dpp v7, v7, v7 row_ror:1 row_mask:0xf bank_mask:0xf
    v_add_f32_dpp v8, v8, v8 row_ror:1 row_mask:0xf bank_mask:0xf
    v_add_f32_dpp v9, v9, v9 row_ror:1 row_mask:0xf bank_mask:0xf
    v_cndmask_b32 v13, v13, v6, s[64:65]
    s_lshl_b64 s[64:65], s[64:65], 1
    v_cndmask_b32 v13, v13, v7, s[64:65]
    s_lshl_b64 s[64:65], s[64:65], 1
    v_cndmask_b32 v13, v13, v8, s[64:65]
    s_lshl_b64 s[64:65], s[64:65], 1
    v_cndmask_b32 v13, v13, v9, s[64:65]
    s_lshl_b64 s[64:65], s[64:65], 1
    s_waitcnt vmcnt(6)
    v_dot2_f32_bf16 v6, v64, v2, 0
    v_dot2_f32_bf16 v7, v68, v2, 0
    v_dot2_f32_bf16 v8, v72, v2, 0
    v_dot2_f32_bf16 v9, v76, v2, 0
    v_dot2_f32_bf16 v6, v65, v3, v6
    v_dot2_f32_bf16 v7, v69, v3, v7
    v_dot2_f32_bf16 v8, v73, v3, v8
    v_dot2_f32_bf16 v9, v77, v3, v9
    v_dot2_f32_bf16 v6, v66, v4, v6
    v_dot2_f32_bf16 v7, v70, v4, v7
    v_dot2_f32_bf16 v8, v74, v4, v8
    v_dot2_f32_bf16 v9, v78, v4, v9
    v_dot2_f32_bf16 v6, v67, v5, v6
    v_dot2_f32_bf16 v7, v71, v5, v7
    v_dot2_f32_bf16 v8, v75, v5, v8
    v_dot2_f32_bf16 v9, v79, v5, v9
    s_waitcnt vmcnt(5)
    buffer_load_dwordx4 v[104:107], v1, s[12:15], s60 offen nt
    s_add_u32 s60, s60, 4096
    s_and_b32 s60, s60, 0x3ffff
    v_add_f32_dpp v6, v6, v6 row_ror:8 row_mask:0xf bank_mask:0xf
    v_add_f32_dpp v7, v7, v7 row_ror:8 row_mask:0xf bank_mask:0xf
    v_add_f32_dpp v8, v8, v8 row_ror:8 row_mask:0xf bank_mask:0xf
    v_add_f32_dpp v9, v9, v9 row_ror:8 row_mask:0xf bank_mask:0xf
    s_waitcnt vmcnt(5)
    buffer_load_dwordx4 v[108:111], v1, s[12:15], s60 offen nt
    s_add_u32 s60, s60, 4096
    s_and_b32 s60, s60, 0x3ffff
    v_add_f32_dpp v6, v6, v6 row_ror:4 row_mask:0xf bank_mask:0xf
    v_add_f32_dpp v7, v7, v7 row_ror:4 row_mask:0xf bank_mask:0xf
    v_add_f32_dpp v8, v8, v8 row_ror:4 row_mask:0xf bank_mask:0xf
    v_add_f32_dpp v9, v9, v9 row_ror:4 row_mask:0xf bank_mask:0xf
    s_waitcnt vmcnt(5)
    buffer_load_dwordx4 v[112:115], v1, s[12:15], s60 offen nt
    s_add_u32 s60, s60, 4096
    s_and_b32 s60, s60, 0x3ffff
    v_add_f32_dpp v6, v6, v6 row_ror:2 row_mask:0xf bank_mask:0xf
    v_add_f32_dpp v7, v7, v7 row_ror:2 row_mask:0xf bank_mask:0xf
    v_add_f32_dpp v8, v8, v8 row_ror:2 row_mask:0xf bank_mask:0xf
    v_add_f32_dpp v9, v9, v9 row_ror:2 row_mask:0xf bank_mask:0xf
    s_waitcnt vmcnt(5)
    buffer_load_dwordx4 v[116:119], v1, s[12:15], s60 offen nt
    s_add_u32 s60, s60, 4096
    s_and_b32 s60, s60, 0x3ffff
    v_add_f32_dpp v6, v6, v6 row_ror:1 row_mask:0xf bank_mask:0xf
    v_add_f32_dpp v7, v7, v7 row_ror:1 row_mask:0xf bank_mask:0xf
    v_add_f32_dpp v8, v8, v8 row_ror:1 row_mask:0xf bank_mask:0xf
    v_add_f32_dpp v9, v9, v9 row_ror:1 row_mask:0xf bank_mask:0xf
    v_cndmask_b32 v13, v13, v6, s[64:65]
    s_lshl_b64 s[64:65], s[64:65], 1
    v_cndmask_b32 v13, v13, v7, s[64:65]
    s_lshl_b64 s[64:65], s[64:65], 1
    v_cndmask_b32 v13, v13, v8, s[64:65]
    s_lshl_b64 s[64:65], s[64:65], 1
    v_cndmask_b32 v13, v13, v9, s[64:65]
    s_lshl_b64 s[64:65], s[64:65], 1
    s_waitcnt vmcnt(6)
    v_dot2_f32_bf16 v6, v80, v2, 0
    v_dot2_f32_bf16 v7, v84, v2, 0
    v_dot2_f32_bf16 v8, v88, v2, 0
    v_dot2_f32_bf16 v9, v92, v2, 0
    v_dot2_f32_bf16 v6, v81, v3, v6
    v_dot2_f32_bf16 v7, v85, v3, v7
    v_dot2_f32_bf16 v8, v89, v3, v8
    v_dot2_f32_bf16 v9, v93, v3, v9
    v_dot2_f32_bf16 v6, v82, v4, v6
    v_dot2_f32_bf16 v7, v86, v4, v7
    v_dot2_f32_bf16 v8, v90, v4, v8
    v_dot2_f32_bf16 v9, v94, v4, v9
    v_dot2_f32_bf16 v6, v83, v5, v6
    v_dot2_f32_bf16 v7, v87, v5, v7
    v_dot2_f32_bf16 v8, v91, v5, v8
    v_dot2_f32_bf16 v9, v95, v5, v9
    v_add_f32_dpp v6, v6, v6 row_ror:8 row_mask:0xf bank_mask:0xf
    v_add_f32_dpp v7, v7, v7 row_ror:8 row_mask:0xf bank_mask:0xf
    v_add_f32_dpp v8, v8, v8 row_ror:8 row_mask:0xf bank_mask:0xf
    v_add_f32_dpp v9, v9, v9 row_ror:8 row_mask:0xf bank_mask:0xf
    s_waitcnt vmcnt(5)
    buffer_load_dwordx4 v[120:123], v1, s[12:15], s60 offen nt
    s_add_u32 s60, s60, 4096
    s_and_b32 s60, s60, 0x3ffff
    v_add_f32_dpp v6, v6, v6 row_ror:4 row_mask:0xf bank_mask:0xf
    v_add_f32_dpp v7, v7, v7 row_ror:4 row_mask:0xf bank_mask:0xf
    v_add_f32_dpp v8, v8, v8 row_ror:4 row_mask:0xf bank_mask:0xf
    v_add_f32_dpp v9, v9, v9 row_ror:4 row_mask:0xf bank_mask:0xf
    v_add_f32_dpp v6, v6, v6 row_ror:2 row_mask:0xf bank_mask:0xf
    v_add_f32_dpp v7, v7, v7 row_ror:2 row_mask:0xf bank_mask:0xf
    v_add_f32_dpp v8, v8, v8 row_ror:2 row_mask:0xf bank_mask:0xf
    v_add_f32_dpp v9, v9, v9 row_ror:2 row_mask:0xf bank_mask:0xf
    v_add_f32_dpp v6, v6, v6 row_ror:1 row_mask:0xf bank_mask:0xf
    v_add_f32_dpp v7, v7, v7 row_ror:1 row_mask:0xf bank_mask:0xf
    v_add_f32_dpp v8, v8, v8 row_ror:1 row_mask:0xf bank_mask:0xf
    v_add_f32_dpp v9, v9, v9 row_ror:1 row_mask:0xf bank_mask:0xf
    v_cndmask_b32 v13, v13, v6, s[64:65]
    s_lshl_b64 s[64:65], s[64:65], 1
    v_cndmask_b32 v13, v13, v7, s[64:65]
    s_lshl_b64 s[64:65], s[64:65], 1
    v_cndmask_b32 v13, v13, v8, s[64:65]
    s_lshl_b64 s[64:65], s[64:65], 1
    v_cndmask_b32 v13, v13, v9, s[64:65]
    s_mov_b32 s64, 0x00010001
    s_mov_b32 s65, 0x00010001
    v_cvt_pk_bf16_f32 v30, v10, v11
    v_cvt_pk_bf16_f32 v31, v12, v13
    v_lshlrev_b32 v10, 16, v30
    v_and_b32 v11, 0xffff0000, v30
    v_lshlrev_b32 v12, 16, v31
    v_and_b32 v13, 0xffff0000, v31
    v_mul_f32 v10, 0x3db504f3, v10
    v_mul_f32 v11, 0x3db504f3, v11
    v_mul_f32 v12, 0x3db504f3, v12
    v_mul_f32 v13, 0x3db504f3, v13
    s_waitcnt vmcnt(5)
    buffer_load_dwordx4 v[124:127], v1, s[12:15], s60 offen nt
    s_add_u32 s60, s60, 4096
    s_and_b32 s60, s60, 0x3ffff
    v_cvt_pk_bf16_f32 v30, v10, v11
    v_cvt_pk_bf16_f32 v31, v12, v13
    v_lshlrev_b32 v10, 16, v30
    v_and_b32 v11, 0xffff0000, v30
    v_lshlrev_b32 v12, 16, v31
    v_and_b32 v13, 0xffff0000, v31
    v_max3_f32 v32, v10, v11, v12
    v_max_f32 v32, v32, v13
    s_nop 1
    v_max_f32_dpp v32, v32, v32 row_ror:8 row_mask:0xf bank_mask:0xf
    s_nop 1
    v_max_f32_dpp v32, v32, v32 row_ror:4 row_mask:0xf bank_mask:0xf
    s_nop 1
    v_max_f32_dpp v32, v32, v32 row_ror:2 row_mask:0xf bank_mask:0xf
    s_nop 1
    v_max_f32_dpp v32, v32, v32 row_ror:1 row_mask:0xf bank_mask:0xf
    s_waitcnt vmcnt(5)
    buffer_load_dwordx4 v[128:131], v1, s[12:15], s60 offen nt
    s_add_u32 s60, s60, 4096
    s_and_b32 s60, s60, 0x3ffff
    v_mov_b32 v30, v32
    s_nop 1
    v_permlane16_swap_b32 v32, v30
    v_max_f32 v32, v32, v30
    v_mov_b32 v30, v32
    s_nop 1
    v_permlane32_swap_b32 v32, v30
    v_max_f32 v32, v32, v30
    v_sub_f32 v10, v10, v32
    v_sub_f32 v11, v11, v32
    v_sub_f32 v12, v12, v32
    v_sub_f32 v13, v13, v32
    v_mul_f32 v10, 0x3fb8aa3b, v10
    v_mul_f32 v11, 0x3fb8aa3b, v11
    v_mul_f32 v12, 0x3fb8aa3b, v12
    v_mul_f32 v13, 0x3fb8aa3b, v13
    v_exp_f32 v10, v10
    v_exp_f32 v11, v11
    v_exp_f32 v12, v12
    v_exp_f32 v13, v13
    s_waitcnt vmcnt(5)
    buffer_load_dwordx4 v[132:135], v1, s[12:15], s60 offen nt
    s_add_u32 s60, s60, 4096
    s_and_b32 s60, s60, 0x3ffff
    v_add_f32 v33, v10, v11
    v_add_f32 v30, v12, v13
    v_add_f32 v33, v33, v30
    v_cvt_pk_bf16_f32 v10, v10, v10
    v_cvt_pk_bf16_f32 v11, v11, v11
    v_cvt_pk_bf16_f32 v12, v12, v12
    v_cvt_pk_bf16_f32 v13, v13, v13
    v_and_b32_dpp v18, v10, v14 row_newbcast:0 row_mask:0xf bank_mask:0xf
    v_and_b32_dpp v19, v10, v15 row_newbcast:0 row_mask:0xf bank_mask:0xf
    v_and_b32_dpp v20, v10, v16 row_newbcast:0 row_mask:0xf bank_mask:0xf
    v_and_b32_dpp v21, v10, v17 row_newbcast:0 row_mask:0xf bank_mask:0xf
    v_add_f32_dpp v33, v33, v33 row_ror:8 row_mask:0xf bank_mask:0xf
    s_nop 1
    v_add_f32_dpp v33, v33, v33 row_ror:4 row_mask:0xf bank_mask:0xf
    s_nop 1
    v_add_f32_dpp v33, v33, v33 row_ror:2 row_mask:0xf bank_mask:0xf
    s_nop 1
    v_add_f32_dpp v33, v33, v33 row_ror:1 row_mask:0xf bank_mask:0xf
    v_mov_b32 v30, v33
    s_nop 1
    v_permlane16_swap_b32 v33, v30
    v_add_f32 v33, v33, v30
    v_mov_b32 v30, v33
    s_nop 1
    v_permlane32_swap_b32 v33, v30
    v_add_f32 v33, v33, v30
    v_lshrrev_b32 v30, 4, v0
    v_lshlrev_b32 v30, 7, v30
    v_and_b32 v31, 15, v0
    v_add_u32 v30, v30, v34
    s_sub_u32 s61, s3, 4
    s_lshl_b32 s62, s61, 9
    v_add_u32 v30, s62, v30
    v_mov_b32 v35, s62
    v_cmp_gt_u32 s[66:67], 8, v31
    s_mov_b64 exec, 1
    ds_write_b64 v35, v[32:33] offset:20480
    v_mov_b32 v44, 0
    v_mov_b32 v45, 1
    ds_add_u32 v44, v45 offset:28
    s_mov_b64 exec, -1
    v_and_b32_dpp v22, v10, v14 row_newbcast:1 row_mask:0xf bank_mask:0xf
    v_and_b32_dpp v23, v10, v15 row_newbcast:1 row_mask:0xf bank_mask:0xf
    v_and_b32_dpp v24, v10, v16 row_newbcast:1 row_mask:0xf bank_mask:0xf
    v_and_b32_dpp v25, v10, v17 row_newbcast:1 row_mask:0xf bank_mask:0xf
    s_waitcnt vmcnt(5)
    v_mfma_f32_16x16x32_bf16 v[26:29], v[96:99], v[18:21], 0
    buffer_load_dwordx4 v[136:139], v1, s[12:15], s60 offen nt
    s_add_u32 s60, s60, 4096
    s_and_b32 s60, s60, 0x3ffff
    v_and_b32_dpp v18, v10, v14 row_newbcast:2 row_mask:0xf bank_mask:0xf
    v_and_b32_dpp v19, v10, v15 row_newbcast:2 row_mask:0xf bank_mask:0xf
    v_and_b32_dpp v20, v10, v16 row_newbcast:2 row_mask:0xf bank_mask:0xf
    v_and_b32_dpp v21, v10, v17 row_newbcast:2 row_mask:0xf bank_mask:0xf
    s_waitcnt vmcnt(5)
    v_mfma_f32_16x16x32_bf16 v[26:29], v[100:103], v[22:25], v[26:29]
    buffer_load_dwordx4 v[140:143], v1, s[12:15], s60 offen nt
    s_add_u32 s60, s60, 4096
    s_and_b32 s60, s60, 0x3ffff
    v_and_b32_dpp v22, v10, v14 row_newbcast:3 row_mask:0xf bank_mask:0xf
    v_and_b32_dpp v23, v10, v15 row_newbcast:3 row_mask:0xf bank_mask:0xf
    v_and_b32_dpp v24, v10, v16 row_newbcast:3 row_mask:0xf bank_mask:0xf
    v_and_b32_dpp v25, v10, v17 row_newbcast:3 row_mask:0xf bank_mask:0xf
    s_waitcnt vmcnt(5)
    v_mfma_f32_16x16x32_bf16 v[26:29], v[104:107], v[18:21], v[26:29]
    buffer_load_dwordx4 v[144:147], v1, s[12:15], s60 offen nt
    s_add_u32 s60, s60, 4096
    s_and_b32 s60, s60, 0x3ffff
    v_and_b32_dpp v18, v10, v14 row_newbcast:4 row_mask:0xf bank_mask:0xf
    v_and_b32_dpp v19, v10, v15 row_newbcast:4 row_mask:0xf bank_mask:0xf
    v_and_b32_dpp v20, v10, v16 row_newbcast:4 row_mask:0xf bank_mask:0xf
    v_and_b32_dpp v21, v10, v17 row_newbcast:4 row_mask:0xf bank_mask:0xf
    s_waitcnt vmcnt(5)
    v_mfma_f32_16x16x32_bf16 v[26:29], v[108:111], v[22:25], v[26:29]
    buffer_load_dwordx4 v[148:151], v1, s[12:15], s60 offen nt
    s_add_u32 s60, s60, 4096
    s_and_b32 s60, s60, 0x3ffff
    v_and_b32_dpp v22, v10, v14 row_newbcast:5 row_mask:0xf bank_mask:0xf
    v_and_b32_dpp v23, v10, v15 row_newbcast:5 row_mask:0xf bank_mask:0xf
    v_and_b32_dpp v24, v10, v16 row_newbcast:5 row_mask:0xf bank_mask:0xf
    v_and_b32_dpp v25, v10, v17 row_newbcast:5 row_mask:0xf bank_mask:0xf
    s_waitcnt vmcnt(5)
    v_mfma_f32_16x16x32_bf16 v[26:29], v[112:115], v[18:21], v[26:29]
    buffer_load_dwordx4 v[152:155], v1, s[12:15], s60 offen nt
    s_add_u32 s60, s60, 4096
    s_and_b32 s60, s60, 0x3ffff
    v_and_b32_dpp v18, v10, v14 row_newbcast:6 row_mask:0xf bank_mask:0xf
    v_and_b32_dpp v19, v10, v15 row_newbcast:6 row_mask:0xf bank_mask:0xf
    v_and_b32_dpp v20, v10, v16 row_newbcast:6 row_mask:0xf bank_mask:0xf
    v_and_b32_dpp v21, v10, v17 row_newbcast:6 row_mask:0xf bank_mask:0xf
    s_waitcnt vmcnt(5)
    v_mfma_f32_16x16x32_bf16 v[26:29], v[116:119], v[22:25], v[26:29]
    buffer_load_dwordx4 v[156:159], v1, s[12:15], s60 offen nt
    s_add_u32 s60, s60, 4096
    s_and_b32 s60, s60, 0x3ffff
    v_and_b32_dpp v22, v10, v14 row_newbcast:7 row_mask:0xf bank_mask:0xf
    v_and_b32_dpp v23, v10, v15 row_newbcast:7 row_mask:0xf bank_mask:0xf
    v_and_b32_dpp v24, v10, v16 row_newbcast:7 row_mask:0xf bank_mask:0xf
    v_and_b32_dpp v25, v10, v17 row_newbcast:7 row_mask:0xf bank_mask:0xf
    s_waitcnt vmcnt(5)
    v_mfma_f32_16x16x32_bf16 v[26:29], v[120:123], v[18:21], v[26:29]
    buffer_load_dwordx4 v[160:163], v1, s[12:15], s60 offen nt
    s_add_u32 s60, s60, 4096
    s_and_b32 s60, s60, 0x3ffff
    v_and_b32_dpp v18, v10, v14 row_newbcast:8 row_mask:0xf bank_mask:0xf
    v_and_b32_dpp v19, v10, v15 row_newbcast:8 row_mask:0xf bank_mask:0xf
    v_and_b32_dpp v20, v10, v16 row_newbcast:8 row_mask:0xf bank_mask:0xf
    v_and_b32_dpp v21, v10, v17 row_newbcast:8 row_mask:0xf bank_mask:0xf
    s_waitcnt vmcnt(5)
    v_mfma_f32_16x16x32_bf16 v[26:29], v[124:127], v[22:25], v[26:29]
    buffer_load_dwordx4 v[164:167], v1, s[12:15], s60 offen nt
    s_add_u32 s60, s60, 4096
    s_and_b32 s60, s60, 0x3ffff
    v_and_b32_dpp v22, v10, v14 row_newbcast:9 row_mask:0xf bank_mask:0xf
    v_and_b32_dpp v23, v10, v15 row_newbcast:9 row_mask:0xf bank_mask:0xf
    v_and_b32_dpp v24, v10, v16 row_newbcast:9 row_mask:0xf bank_mask:0xf
    v_and_b32_dpp v25, v10, v17 row_newbcast:9 row_mask:0xf bank_mask:0xf
    s_waitcnt vmcnt(5)
    v_mfma_f32_16x16x32_bf16 v[26:29], v[128:131], v[18:21], v[26:29]
    buffer_load_dwordx4 v[168:171], v1, s[12:15], s60 offen nt
    s_add_u32 s60, s60, 4096
    s_and_b32 s60, s60, 0x3ffff
    v_and_b32_dpp v18, v10, v14 row_newbcast:10 row_mask:0xf bank_mask:0xf
    v_and_b32_dpp v19, v10, v15 row_newbcast:10 row_mask:0xf bank_mask:0xf
    v_and_b32_dpp v20, v10, v16 row_newbcast:10 row_mask:0xf bank_mask:0xf
    v_and_b32_dpp v21, v10, v17 row_newbcast:10 row_mask:0xf bank_mask:0xf
    s_waitcnt vmcnt(5)
    v_mfma_f32_16x16x32_bf16 v[26:29], v[132:135], v[22:25], v[26:29]
    buffer_load_dwordx4 v[172:175], v1, s[12:15], s60 offen nt
    s_add_u32 s60, s60, 4096
    s_and_b32 s60, s60, 0x3ffff
    v_and_b32_dpp v22, v10, v14 row_newbcast:11 row_mask:0xf bank_mask:0xf
    v_and_b32_dpp v23, v10, v15 row_newbcast:11 row_mask:0xf bank_mask:0xf
    v_and_b32_dpp v24, v10, v16 row_newbcast:11 row_mask:0xf bank_mask:0xf
    v_and_b32_dpp v25, v10, v17 row_newbcast:11 row_mask:0xf bank_mask:0xf
    s_waitcnt vmcnt(5)
    v_mfma_f32_16x16x32_bf16 v[26:29], v[136:139], v[18:21], v[26:29]
    buffer_load_dwordx4 v[176:179], v1, s[12:15], s60 offen nt
    s_add_u32 s60, s60, 4096
    s_and_b32 s60, s60, 0x3ffff
    v_and_b32_dpp v18, v10, v14 row_newbcast:12 row_mask:0xf bank_mask:0xf
    v_and_b32_dpp v19, v10, v15 row_newbcast:12 row_mask:0xf bank_mask:0xf
    v_and_b32_dpp v20, v10, v16 row_newbcast:12 row_mask:0xf bank_mask:0xf
    v_and_b32_dpp v21, v10, v17 row_newbcast:12 row_mask:0xf bank_mask:0xf
    s_waitcnt vmcnt(5)
    v_mfma_f32_16x16x32_bf16 v[26:29], v[140:143], v[22:25], v[26:29]
    buffer_load_dwordx4 v[180:183], v1, s[12:15], s60 offen nt
    s_add_u32 s60, s60, 4096
    s_and_b32 s60, s60, 0x3ffff
    v_and_b32_dpp v22, v10, v14 row_newbcast:13 row_mask:0xf bank_mask:0xf
    v_and_b32_dpp v23, v10, v15 row_newbcast:13 row_mask:0xf bank_mask:0xf
    v_and_b32_dpp v24, v10, v16 row_newbcast:13 row_mask:0xf bank_mask:0xf
    v_and_b32_dpp v25, v10, v17 row_newbcast:13 row_mask:0xf bank_mask:0xf
    s_waitcnt vmcnt(5)
    v_mfma_f32_16x16x32_bf16 v[26:29], v[144:147], v[18:21], v[26:29]
    buffer_load_dwordx4 v[184:187], v1, s[12:15], s60 offen nt
    s_add_u32 s60, s60, 4096
    s_and_b32 s60, s60, 0x3ffff
    v_and_b32_dpp v18, v10, v14 row_newbcast:14 row_mask:0xf bank_mask:0xf
    v_and_b32_dpp v19, v10, v15 row_newbcast:14 row_mask:0xf bank_mask:0xf
    v_and_b32_dpp v20, v10, v16 row_newbcast:14 row_mask:0xf bank_mask:0xf
    v_and_b32_dpp v21, v10, v17 row_newbcast:14 row_mask:0xf bank_mask:0xf
    s_waitcnt vmcnt(5)
    v_mfma_f32_16x16x32_bf16 v[26:29], v[148:151], v[22:25], v[26:29]
    buffer_load_dwordx4 v[188:191], v1, s[12:15], s60 offen nt
    s_add_u32 s60, s60, 4096
    s_and_b32 s60, s60, 0x3ffff
    v_and_b32_dpp v22, v10, v14 row_newbcast:15 row_mask:0xf bank_mask:0xf
    v_and_b32_dpp v23, v10, v15 row_newbcast:15 row_mask:0xf bank_mask:0xf
    v_and_b32_dpp v24, v10, v16 row_newbcast:15 row_mask:0xf bank_mask:0xf
    v_and_b32_dpp v25, v10, v17 row_newbcast:15 row_mask:0xf bank_mask:0xf
    s_waitcnt vmcnt(5)
    v_mfma_f32_16x16x32_bf16 v[26:29], v[152:155], v[18:21], v[26:29]
    buffer_load_dwordx4 v[192:195], v1, s[12:15], s60 offen nt
    s_add_u32 s60, s60, 4096
    s_and_b32 s60, s60, 0x3ffff
    v_and_b32_dpp v18, v11, v14 row_newbcast:0 row_mask:0xf bank_mask:0xf
    v_and_b32_dpp v19, v11, v15 row_newbcast:0 row_mask:0xf bank_mask:0xf
    v_and_b32_dpp v20, v11, v16 row_newbcast:0 row_mask:0xf bank_mask:0xf
    v_and_b32_dpp v21, v11, v17 row_newbcast:0 row_mask:0xf bank_mask:0xf
    s_waitcnt vmcnt(5)
    v_mfma_f32_16x16x32_bf16 v[26:29], v[156:159], v[22:25], v[26:29]
    buffer_load_dwordx4 v[196:199], v1, s[12:15], s60 offen nt
    s_add_u32 s60, s60, 4096
    s_and_b32 s60, s60, 0x3ffff
    v_and_b32_dpp v22, v11, v14 row_newbcast:1 row_mask:0xf bank_mask:0xf
    v_and_b32_dpp v23, v11, v15 row_newbcast:1 row_mask:0xf bank_mask:0xf
    v_and_b32_dpp v24, v11, v16 row_newbcast:1 row_mask:0xf bank_mask:0xf
    v_and_b32_dpp v25, v11, v17 row_newbcast:1 row_mask:0xf bank_mask:0xf
    s_waitcnt vmcnt(5)
    v_mfma_f32_16x16x32_bf16 v[26:29], v[160:163], v[18:21], v[26:29]
    buffer_load_dwordx4 v[200:203], v1, s[12:15], s60 offen nt
    s_add_u32 s60, s60, 4096
    s_and_b32 s60, s60, 0x3ffff
    v_and_b32_dpp v18, v11, v14 row_newbcast:2 row_mask:0xf bank_mask:0xf
    v_and_b32_dpp v19, v11, v15 row_newbcast:2 row_mask:0xf bank_mask:0xf
    v_and_b32_dpp v20, v11, v16 row_newbcast:2 row_mask:0xf bank_mask:0xf
    v_and_b32_dpp v21, v11, v17 row_newbcast:2 row_mask:0xf bank_mask:0xf
    s_waitcnt vmcnt(5)
    v_mfma_f32_16x16x32_bf16 v[26:29], v[164:167], v[22:25], v[26:29]
    buffer_load_dwordx4 v[204:207], v1, s[12:15], s60 offen nt
    s_add_u32 s60, s60, 4096
    s_and_b32 s60, s60, 0x3ffff
    v_and_b32_dpp v22, v11, v14 row_newbcast:3 row_mask:0xf bank_mask:0xf
    v_and_b32_dpp v23, v11, v15 row_newbcast:3 row_mask:0xf bank_mask:0xf
    v_and_b32_dpp v24, v11, v16 row_newbcast:3 row_mask:0xf bank_mask:0xf
    v_and_b32_dpp v25, v11, v17 row_newbcast:3 row_mask:0xf bank_mask:0xf
    s_waitcnt vmcnt(5)
    v_mfma_f32_16x16x32_bf16 v[26:29], v[168:171], v[18:21], v[26:29]
    buffer_load_dwordx4 v[208:211], v1, s[12:15], s60 offen nt
    s_add_u32 s60, s60, 4096
    s_and_b32 s60, s60, 0x3ffff
    v_and_b32_dpp v18, v11, v14 row_newbcast:4 row_mask:0xf bank_mask:0xf
    v_and_b32_dpp v19, v11, v15 row_newbcast:4 row_mask:0xf bank_mask:0xf
    v_and_b32_dpp v20, v11, v16 row_newbcast:4 row_mask:0xf bank_mask:0xf
    v_and_b32_dpp v21, v11, v17 row_newbcast:4 row_mask:0xf bank_mask:0xf
    s_waitcnt vmcnt(5)
    v_mfma_f32_16x16x32_bf16 v[26:29], v[172:175], v[22:25], v[26:29]
    buffer_load_dwordx4 v[212:215], v1, s[12:15], s60 offen nt
    s_add_u32 s60, s60, 4096
    s_and_b32 s60, s60, 0x3ffff
    v_and_b32_dpp v22, v11, v14 row_newbcast:5 row_mask:0xf bank_mask:0xf
    v_and_b32_dpp v23, v11, v15 row_newbcast:5 row_mask:0xf bank_mask:0xf
    v_and_b32_dpp v24, v11, v16 row_newbcast:5 row_mask:0xf bank_mask:0xf
    v_and_b32_dpp v25, v11, v17 row_newbcast:5 row_mask:0xf bank_mask:0xf
    s_waitcnt vmcnt(5)
    v_mfma_f32_16x16x32_bf16 v[26:29], v[176:179], v[18:21], v[26:29]
    buffer_load_dwordx4 v[216:219], v1, s[12:15], s60 offen nt
    s_add_u32 s60, s60, 4096
    s_and_b32 s60, s60, 0x3ffff
    v_and_b32_dpp v18, v11, v14 row_newbcast:6 row_mask:0xf bank_mask:0xf
    v_and_b32_dpp v19, v11, v15 row_newbcast:6 row_mask:0xf bank_mask:0xf
    v_and_b32_dpp v20, v11, v16 row_newbcast:6 row_mask:0xf bank_mask:0xf
    v_and_b32_dpp v21, v11, v17 row_newbcast:6 row_mask:0xf bank_mask:0xf
    s_waitcnt vmcnt(5)
    v_mfma_f32_16x16x32_bf16 v[26:29], v[180:183], v[22:25], v[26:29]
    buffer_load_dwordx4 v[220:223], v1, s[12:15], s60 offen nt
    s_add_u32 s60, s60, 4096
    s_and_b32 s60, s60, 0x3ffff
    v_and_b32_dpp v22, v11, v14 row_newbcast:7 row_mask:0xf bank_mask:0xf
    v_and_b32_dpp v23, v11, v15 row_newbcast:7 row_mask:0xf bank_mask:0xf
    v_and_b32_dpp v24, v11, v16 row_newbcast:7 row_mask:0xf bank_mask:0xf
    v_and_b32_dpp v25, v11, v17 row_newbcast:7 row_mask:0xf bank_mask:0xf
    s_waitcnt vmcnt(5)
    v_mfma_f32_16x16x32_bf16 v[26:29], v[184:187], v[18:21], v[26:29]
    buffer_load_dwordx4 v[224:227], v1, s[12:15], s60 offen nt
    s_add_u32 s60, s60, 4096
    s_and_b32 s60, s60, 0x3ffff
    v_and_b32_dpp v18, v11, v14 row_newbcast:8 row_mask:0xf bank_mask:0xf
    v_and_b32_dpp v19, v11, v15 row_newbcast:8 row_mask:0xf bank_mask:0xf
    v_and_b32_dpp v20, v11, v16 row_newbcast:8 row_mask:0xf bank_mask:0xf
    v_and_b32_dpp v21, v11, v17 row_newbcast:8 row_mask:0xf bank_mask:0xf
    s_waitcnt vmcnt(5)
    v_mfma_f32_16x16x32_bf16 v[26:29], v[188:191], v[22:25], v[26:29]
    buffer_load_dwordx4 v[228:231], v1, s[12:15], s60 offen nt
    s_add_u32 s60, s60, 4096
    s_and_b32 s60, s60, 0x3ffff
    v_and_b32_dpp v22, v11, v14 row_newbcast:9 row_mask:0xf bank_mask:0xf
    v_and_b32_dpp v23, v11, v15 row_newbcast:9 row_mask:0xf bank_mask:0xf
    v_and_b32_dpp v24, v11, v16 row_newbcast:9 row_mask:0xf bank_mask:0xf
    v_and_b32_dpp v25, v11, v17 row_newbcast:9 row_mask:0xf bank_mask:0xf
    s_waitcnt vmcnt(5)
    v_mfma_f32_16x16x32_bf16 v[26:29], v[192:195], v[18:21], v[26:29]
    buffer_load_dwordx4 v[232:235], v1, s[12:15], s60 offen nt
    s_add_u32 s60, s60, 4096
    s_and_b32 s60, s60, 0x3ffff
    v_and_b32_dpp v18, v11, v14 row_newbcast:10 row_mask:0xf bank_mask:0xf
    v_and_b32_dpp v19, v11, v15 row_newbcast:10 row_mask:0xf bank_mask:0xf
    v_and_b32_dpp v20, v11, v16 row_newbcast:10 row_mask:0xf bank_mask:0xf
    v_and_b32_dpp v21, v11, v17 row_newbcast:10 row_mask:0xf bank_mask:0xf
    s_waitcnt vmcnt(5)
    v_mfma_f32_16x16x32_bf16 v[26:29], v[196:199], v[22:25], v[26:29]
    buffer_load_dwordx4 v[236:239], v1, s[12:15], s60 offen nt
    s_add_u32 s60, s60, 4096
    s_and_b32 s60, s60, 0x3ffff
    v_and_b32_dpp v22, v11, v14 row_newbcast:11 row_mask:0xf bank_mask:0xf
    v_and_b32_dpp v23, v11, v15 row_newbcast:11 row_mask:0xf bank_mask:0xf
    v_and_b32_dpp v24, v11, v16 row_newbcast:11 row_mask:0xf bank_mask:0xf
    v_and_b32_dpp v25, v11, v17 row_newbcast:11 row_mask:0xf bank_mask:0xf
    s_waitcnt vmcnt(5)
    v_mfma_f32_16x16x32_bf16 v[26:29], v[200:203], v[18:21], v[26:29]
    buffer_load_dwordx4 v[240:243], v1, s[12:15], s60 offen nt
    s_add_u32 s60, s60, 4096
    s_and_b32 s60, s60, 0x3ffff
    v_and_b32_dpp v18, v11, v14 row_newbcast:12 row_mask:0xf bank_mask:0xf
    v_and_b32_dpp v19, v11, v15 row_newbcast:12 row_mask:0xf bank_mask:0xf
    v_and_b32_dpp v20, v11, v16 row_newbcast:12 row_mask:0xf bank_mask:0xf
    v_and_b32_dpp v21, v11, v17 row_newbcast:12 row_mask:0xf bank_mask:0xf
    s_waitcnt vmcnt(5)
    v_mfma_f32_16x16x32_bf16 v[26:29], v[204:207], v[22:25], v[26:29]
    buffer_load_dwordx4 v[244:247], v1, s[12:15], s60 offen nt
    s_add_u32 s60, s60, 4096
    s_and_b32 s60, s60, 0x3ffff
    v_and_b32_dpp v22, v11, v14 row_newbcast:13 row_mask:0xf bank_mask:0xf
    v_and_b32_dpp v23, v11, v15 row_newbcast:13 row_mask:0xf bank_mask:0xf
    v_and_b32_dpp v24, v11, v16 row_newbcast:13 row_mask:0xf bank_mask:0xf
    v_and_b32_dpp v25, v11, v17 row_newbcast:13 row_mask:0xf bank_mask:0xf
    s_waitcnt vmcnt(5)
    v_mfma_f32_16x16x32_bf16 v[26:29], v[208:211], v[18:21], v[26:29]
    buffer_load_dwordx4 v[248:251], v1, s[12:15], s60 offen nt
    s_add_u32 s60, s60, 4096
    s_and_b32 s60, s60, 0x3ffff
    v_and_b32_dpp v18, v11, v14 row_newbcast:14 row_mask:0xf bank_mask:0xf
    v_and_b32_dpp v19, v11, v15 row_newbcast:14 row_mask:0xf bank_mask:0xf
    v_and_b32_dpp v20, v11, v16 row_newbcast:14 row_mask:0xf bank_mask:0xf
    v_and_b32_dpp v21, v11, v17 row_newbcast:14 row_mask:0xf bank_mask:0xf
    s_waitcnt vmcnt(5)
    v_mfma_f32_16x16x32_bf16 v[26:29], v[212:215], v[22:25], v[26:29]
    buffer_load_dwordx4 v[252:255], v1, s[12:15], s60 offen nt
    s_add_u32 s60, s60, 4096
    s_and_b32 s60, s60, 0x3ffff
    v_and_b32_dpp v22, v11, v14 row_newbcast:15 row_mask:0xf bank_mask:0xf
    v_and_b32_dpp v23, v11, v15 row_newbcast:15 row_mask:0xf bank_mask:0xf
    v_and_b32_dpp v24, v11, v16 row_newbcast:15 row_mask:0xf bank_mask:0xf
    v_and_b32_dpp v25, v11, v17 row_newbcast:15 row_mask:0xf bank_mask:0xf
    s_waitcnt vmcnt(5)
    v_mfma_f32_16x16x32_bf16 v[26:29], v[216:219], v[18:21], v[26:29]
    buffer_load_dwordx4 v[48:51], v1, s[12:15], s60 offen nt
    s_add_u32 s60, s60, 4096
    s_and_b32 s60, s60, 0x3ffff
    v_and_b32_dpp v18, v12, v14 row_newbcast:0 row_mask:0xf bank_mask:0xf
    v_and_b32_dpp v19, v12, v15 row_newbcast:0 row_mask:0xf bank_mask:0xf
    v_and_b32_dpp v20, v12, v16 row_newbcast:0 row_mask:0xf bank_mask:0xf
    v_and_b32_dpp v21, v12, v17 row_newbcast:0 row_mask:0xf bank_mask:0xf
    s_waitcnt vmcnt(5)
    v_mfma_f32_16x16x32_bf16 v[26:29], v[220:223], v[22:25], v[26:29]
    buffer_load_dwordx4 v[52:55], v1, s[12:15], s60 offen nt
    s_add_u32 s60, s60, 4096
    s_and_b32 s60, s60, 0x3ffff
    v_and_b32_dpp v22, v12, v14 row_newbcast:1 row_mask:0xf bank_mask:0xf
    v_and_b32_dpp v23, v12, v15 row_newbcast:1 row_mask:0xf bank_mask:0xf
    v_and_b32_dpp v24, v12, v16 row_newbcast:1 row_mask:0xf bank_mask:0xf
    v_and_b32_dpp v25, v12, v17 row_newbcast:1 row_mask:0xf bank_mask:0xf
    s_waitcnt vmcnt(5)
    v_mfma_f32_16x16x32_bf16 v[26:29], v[224:227], v[18:21], v[26:29]
    buffer_load_dwordx4 v[56:59], v1, s[12:15], s60 offen nt
    s_add_u32 s60, s60, 4096
    s_and_b32 s60, s60, 0x3ffff
    v_and_b32_dpp v18, v12, v14 row_newbcast:2 row_mask:0xf bank_mask:0xf
    v_and_b32_dpp v19, v12, v15 row_newbcast:2 row_mask:0xf bank_mask:0xf
    v_and_b32_dpp v20, v12, v16 row_newbcast:2 row_mask:0xf bank_mask:0xf
    v_and_b32_dpp v21, v12, v17 row_newbcast:2 row_mask:0xf bank_mask:0xf
    s_waitcnt vmcnt(5)
    v_mfma_f32_16x16x32_bf16 v[26:29], v[228:231], v[22:25], v[26:29]
    buffer_load_dwordx4 v[60:63], v1, s[12:15], s60 offen nt
    s_add_u32 s60, s60, 4096
    s_and_b32 s60, s60, 0x3ffff
    v_and_b32_dpp v22, v12, v14 row_newbcast:3 row_mask:0xf bank_mask:0xf
    v_and_b32_dpp v23, v12, v15 row_newbcast:3 row_mask:0xf bank_mask:0xf
    v_and_b32_dpp v24, v12, v16 row_newbcast:3 row_mask:0xf bank_mask:0xf
    v_and_b32_dpp v25, v12, v17 row_newbcast:3 row_mask:0xf bank_mask:0xf
    s_waitcnt vmcnt(5)
    v_mfma_f32_16x16x32_bf16 v[26:29], v[232:235], v[18:21], v[26:29]
    buffer_load_dwordx4 v[64:67], v1, s[12:15], s60 offen nt
    s_add_u32 s60, s60, 4096
    s_and_b32 s60, s60, 0x3ffff
    v_and_b32_dpp v18, v12, v14 row_newbcast:4 row_mask:0xf bank_mask:0xf
    v_and_b32_dpp v19, v12, v15 row_newbcast:4 row_mask:0xf bank_mask:0xf
    v_and_b32_dpp v20, v12, v16 row_newbcast:4 row_mask:0xf bank_mask:0xf
    v_and_b32_dpp v21, v12, v17 row_newbcast:4 row_mask:0xf bank_mask:0xf
    s_waitcnt vmcnt(5)
    v_mfma_f32_16x16x32_bf16 v[26:29], v[236:239], v[22:25], v[26:29]
    buffer_load_dwordx4 v[68:71], v1, s[12:15], s60 offen nt
    s_add_u32 s60, s60, 4096
    s_and_b32 s60, s60, 0x3ffff
    v_and_b32_dpp v22, v12, v14 row_newbcast:5 row_mask:0xf bank_mask:0xf
    v_and_b32_dpp v23, v12, v15 row_newbcast:5 row_mask:0xf bank_mask:0xf
    v_and_b32_dpp v24, v12, v16 row_newbcast:5 row_mask:0xf bank_mask:0xf
    v_and_b32_dpp v25, v12, v17 row_newbcast:5 row_mask:0xf bank_mask:0xf
    s_waitcnt vmcnt(5)
    v_mfma_f32_16x16x32_bf16 v[26:29], v[240:243], v[18:21], v[26:29]
    buffer_load_dwordx4 v[72:75], v1, s[12:15], s60 offen nt
    s_add_u32 s60, s60, 4096
    s_and_b32 s60, s60, 0x3ffff
    v_and_b32_dpp v18, v12, v14 row_newbcast:6 row_mask:0xf bank_mask:0xf
    v_and_b32_dpp v19, v12, v15 row_newbcast:6 row_mask:0xf bank_mask:0xf
    v_and_b32_dpp v20, v12, v16 row_newbcast:6 row_mask:0xf bank_mask:0xf
    v_and_b32_dpp v21, v12, v17 row_newbcast:6 row_mask:0xf bank_mask:0xf
    s_waitcnt vmcnt(5)
    v_mfma_f32_16x16x32_bf16 v[26:29], v[244:247], v[22:25], v[26:29]
    buffer_load_dwordx4 v[76:79], v1, s[12:15], s60 offen nt
    s_add_u32 s60, s60, 4096
    s_and_b32 s60, s60, 0x3ffff
    v_and_b32_dpp v22, v12, v14 row_newbcast:7 row_mask:0xf bank_mask:0xf
    v_and_b32_dpp v23, v12, v15 row_newbcast:7 row_mask:0xf bank_mask:0xf
    v_and_b32_dpp v24, v12, v16 row_newbcast:7 row_mask:0xf bank_mask:0xf
    v_and_b32_dpp v25, v12, v17 row_newbcast:7 row_mask:0xf bank_mask:0xf
    s_waitcnt vmcnt(5)
    v_mfma_f32_16x16x32_bf16 v[26:29], v[248:251], v[18:21], v[26:29]
    buffer_load_dwordx4 v[80:83], v1, s[12:15], s60 offen nt
    s_add_u32 s60, s60, 4096
    s_and_b32 s60, s60, 0x3ffff
    v_and_b32_dpp v18, v12, v14 row_newbcast:8 row_mask:0xf bank_mask:0xf
    v_and_b32_dpp v19, v12, v15 row_newbcast:8 row_mask:0xf bank_mask:0xf
    v_and_b32_dpp v20, v12, v16 row_newbcast:8 row_mask:0xf bank_mask:0xf
    v_and_b32_dpp v21, v12, v17 row_newbcast:8 row_mask:0xf bank_mask:0xf
    s_waitcnt vmcnt(5)
    v_mfma_f32_16x16x32_bf16 v[26:29], v[252:255], v[22:25], v[26:29]
    buffer_load_dwordx4 v[84:87], v1, s[12:15], s60 offen nt
    s_add_u32 s60, s60, 4096
    s_and_b32 s60, s60, 0x3ffff
    v_and_b32_dpp v22, v12, v14 row_newbcast:9 row_mask:0xf bank_mask:0xf
    v_and_b32_dpp v23, v12, v15 row_newbcast:9 row_mask:0xf bank_mask:0xf
    v_and_b32_dpp v24, v12, v16 row_newbcast:9 row_mask:0xf bank_mask:0xf
    v_and_b32_dpp v25, v12, v17 row_newbcast:9 row_mask:0xf bank_mask:0xf
    s_waitcnt vmcnt(5)
    v_mfma_f32_16x16x32_bf16 v[26:29], v[48:51], v[18:21], v[26:29]
    buffer_load_dwordx4 v[88:91], v1, s[12:15], s60 offen nt
    s_add_u32 s60, s60, 4096
    s_and_b32 s60, s60, 0x3ffff
    v_and_b32_dpp v18, v12, v14 row_newbcast:10 row_mask:0xf bank_mask:0xf
    v_and_b32_dpp v19, v12, v15 row_newbcast:10 row_mask:0xf bank_mask:0xf
    v_and_b32_dpp v20, v12, v16 row_newbcast:10 row_mask:0xf bank_mask:0xf
    v_and_b32_dpp v21, v12, v17 row_newbcast:10 row_mask:0xf bank_mask:0xf
    s_waitcnt vmcnt(5)
    v_mfma_f32_16x16x32_bf16 v[26:29], v[52:55], v[22:25], v[26:29]
    buffer_load_dwordx4 v[92:95], v1, s[12:15], s60 offen nt
    s_add_u32 s60, s60, 4096
    s_and_b32 s60, s60, 0x3ffff
    v_and_b32_dpp v22, v12, v14 row_newbcast:11 row_mask:0xf bank_mask:0xf
    v_and_b32_dpp v23, v12, v15 row_newbcast:11 row_mask:0xf bank_mask:0xf
    v_and_b32_dpp v24, v12, v16 row_newbcast:11 row_mask:0xf bank_mask:0xf
    v_and_b32_dpp v25, v12, v17 row_newbcast:11 row_mask:0xf bank_mask:0xf
    s_waitcnt vmcnt(5)
    v_mfma_f32_16x16x32_bf16 v[26:29], v[56:59], v[18:21], v[26:29]
    buffer_load_dwordx4 v[96:99], v1, s[12:15], s60 offen nt
    s_add_u32 s60, s60, 4096
    s_and_b32 s60, s60, 0x3ffff
    v_and_b32_dpp v18, v12, v14 row_newbcast:12 row_mask:0xf bank_mask:0xf
    v_and_b32_dpp v19, v12, v15 row_newbcast:12 row_mask:0xf bank_mask:0xf
    v_and_b32_dpp v20, v12, v16 row_newbcast:12 row_mask:0xf bank_mask:0xf
    v_and_b32_dpp v21, v12, v17 row_newbcast:12 row_mask:0xf bank_mask:0xf
    s_waitcnt vmcnt(5)
    v_mfma_f32_16x16x32_bf16 v[26:29], v[60:63], v[22:25], v[26:29]
    buffer_load_dwordx4 v[100:103], v1, s[12:15], s60 offen nt
    s_add_u32 s60, s60, 4096
    s_and_b32 s60, s60, 0x3ffff
    v_and_b32_dpp v22, v12, v14 row_newbcast:13 row_mask:0xf bank_mask:0xf
    v_and_b32_dpp v23, v12, v15 row_newbcast:13 row_mask:0xf bank_mask:0xf
    v_and_b32_dpp v24, v12, v16 row_newbcast:13 row_mask:0xf bank_mask:0xf
    v_and_b32_dpp v25, v12, v17 row_newbcast:13 row_mask:0xf bank_mask:0xf
    s_waitcnt vmcnt(5)
    v_mfma_f32_16x16x32_bf16 v[26:29], v[64:67], v[18:21], v[26:29]
    buffer_load_dwordx4 v[104:107], v1, s[12:15], s60 offen nt
    s_add_u32 s60, s60, 4096
    s_and_b32 s60, s60, 0x3ffff
    v_and_b32_dpp v18, v12, v14 row_newbcast:14 row_mask:0xf bank_mask:0xf
    v_and_b32_dpp v19, v12, v15 row_newbcast:14 row_mask:0xf bank_mask:0xf
    v_and_b32_dpp v20, v12, v16 row_newbcast:14 row_mask:0xf bank_mask:0xf
    v_and_b32_dpp v21, v12, v17 row_newbcast:14 row_mask:0xf bank_mask:0xf
    s_waitcnt vmcnt(5)
    v_mfma_f32_16x16x32_bf16 v[26:29], v[68:71], v[22:25], v[26:29]
    buffer_load_dwordx4 v[108:111], v1, s[12:15], s60 offen nt
    s_add_u32 s60, s60, 4096
    s_and_b32 s60, s60, 0x3ffff
    v_and_b32_dpp v22, v12, v14 row_newbcast:15 row_mask:0xf bank_mask:0xf
    v_and_b32_dpp v23, v12, v15 row_newbcast:15 row_mask:0xf bank_mask:0xf
    v_and_b32_dpp v24, v12, v16 row_newbcast:15 row_mask:0xf bank_mask:0xf
    v_and_b32_dpp v25, v12, v17 row_newbcast:15 row_mask:0xf bank_mask:0xf
    s_waitcnt vmcnt(5)
    v_mfma_f32_16x16x32_bf16 v[26:29], v[72:75], v[18:21], v[26:29]
    buffer_load_dwordx4 v[112:115], v1, s[12:15], s60 offen nt
    s_add_u32 s60, s60, 4096
    s_and_b32 s60, s60, 0x3ffff
    v_and_b32_dpp v18, v13, v14 row_newbcast:0 row_mask:0xf bank_mask:0xf
    v_and_b32_dpp v19, v13, v15 row_newbcast:0 row_mask:0xf bank_mask:0xf
    v_and_b32_dpp v20, v13, v16 row_newbcast:0 row_mask:0xf bank_mask:0xf
    v_and_b32_dpp v21, v13, v17 row_newbcast:0 row_mask:0xf bank_mask:0xf
    s_waitcnt vmcnt(5)
    v_mfma_f32_16x16x32_bf16 v[26:29], v[76:79], v[22:25], v[26:29]
    buffer_load_dwordx4 v[116:119], v1, s[12:15], s60 offen nt
    s_add_u32 s60, s60, 4096
    s_and_b32 s60, s60, 0x3ffff
    v_and_b32_dpp v22, v13, v14 row_newbcast:1 row_mask:0xf bank_mask:0xf
    v_and_b32_dpp v23, v13, v15 row_newbcast:1 row_mask:0xf bank_mask:0xf
    v_and_b32_dpp v24, v13, v16 row_newbcast:1 row_mask:0xf bank_mask:0xf
    v_and_b32_dpp v25, v13, v17 row_newbcast:1 row_mask:0xf bank_mask:0xf
    s_waitcnt vmcnt(5)
    v_mfma_f32_16x16x32_bf16 v[26:29], v[80:83], v[18:21], v[26:29]
    buffer_load_dwordx4 v[120:123], v1, s[12:15], s60 offen nt
    s_add_u32 s60, s60, 4096
    s_and_b32 s60, s60, 0x3ffff
    v_and_b32_dpp v18, v13, v14 row_newbcast:2 row_mask:0xf bank_mask:0xf
    v_and_b32_dpp v19, v13, v15 row_newbcast:2 row_mask:0xf bank_mask:0xf
    v_and_b32_dpp v20, v13, v16 row_newbcast:2 row_mask:0xf bank_mask:0xf
    v_and_b32_dpp v21, v13, v17 row_newbcast:2 row_mask:0xf bank_mask:0xf
    s_waitcnt vmcnt(5)
    v_mfma_f32_16x16x32_bf16 v[26:29], v[84:87], v[22:25], v[26:29]
    buffer_load_dwordx4 v[124:127], v1, s[12:15], s60 offen nt
    s_add_u32 s60, s60, 4096
    s_and_b32 s60, s60, 0x3ffff
    v_and_b32_dpp v22, v13, v14 row_newbcast:3 row_mask:0xf bank_mask:0xf
    v_and_b32_dpp v23, v13, v15 row_newbcast:3 row_mask:0xf bank_mask:0xf
    v_and_b32_dpp v24, v13, v16 row_newbcast:3 row_mask:0xf bank_mask:0xf
    v_and_b32_dpp v25, v13, v17 row_newbcast:3 row_mask:0xf bank_mask:0xf
    s_waitcnt vmcnt(5)
    v_mfma_f32_16x16x32_bf16 v[26:29], v[88:91], v[18:21], v[26:29]
    buffer_load_dwordx4 v[128:131], v1, s[12:15], s60 offen nt
    s_add_u32 s60, s60, 4096
    s_and_b32 s60, s60, 0x3ffff
    v_and_b32_dpp v18, v13, v14 row_newbcast:4 row_mask:0xf bank_mask:0xf
    v_and_b32_dpp v19, v13, v15 row_newbcast:4 row_mask:0xf bank_mask:0xf
    v_and_b32_dpp v20, v13, v16 row_newbcast:4 row_mask:0xf bank_mask:0xf
    v_and_b32_dpp v21, v13, v17 row_newbcast:4 row_mask:0xf bank_mask:0xf
    s_waitcnt vmcnt(5)
    v_mfma_f32_16x16x32_bf16 v[26:29], v[92:95], v[22:25], v[26:29]
    buffer_load_dwordx4 v[132:135], v1, s[12:15], s60 offen nt
    s_add_u32 s60, s60, 4096
    s_and_b32 s60, s60, 0x3ffff
    v_and_b32_dpp v22, v13, v14 row_newbcast:5 row_mask:0xf bank_mask:0xf
    v_and_b32_dpp v23, v13, v15 row_newbcast:5 row_mask:0xf bank_mask:0xf
    v_and_b32_dpp v24, v13, v16 row_newbcast:5 row_mask:0xf bank_mask:0xf
    v_and_b32_dpp v25, v13, v17 row_newbcast:5 row_mask:0xf bank_mask:0xf
    s_waitcnt vmcnt(5)
    v_mfma_f32_16x16x32_bf16 v[26:29], v[96:99], v[18:21], v[26:29]
    buffer_load_dwordx4 v[136:139], v1, s[12:15], s60 offen nt
    s_add_u32 s60, s60, 4096
    s_and_b32 s60, s60, 0x3ffff
    v_and_b32_dpp v18, v13, v14 row_newbcast:6 row_mask:0xf bank_mask:0xf
    v_and_b32_dpp v19, v13, v15 row_newbcast:6 row_mask:0xf bank_mask:0xf
    v_and_b32_dpp v20, v13, v16 row_newbcast:6 row_mask:0xf bank_mask:0xf
    v_and_b32_dpp v21, v13, v17 row_newbcast:6 row_mask:0xf bank_mask:0xf
    s_waitcnt vmcnt(5)
    v_mfma_f32_16x16x32_bf16 v[26:29], v[100:103], v[22:25], v[26:29]
    buffer_load_dwordx4 v[140:143], v1, s[12:15], s60 offen nt
    s_add_u32 s60, s60, 4096
    s_and_b32 s60, s60, 0x3ffff
    v_and_b32_dpp v22, v13, v14 row_newbcast:7 row_mask:0xf bank_mask:0xf
    v_and_b32_dpp v23, v13, v15 row_newbcast:7 row_mask:0xf bank_mask:0xf
    v_and_b32_dpp v24, v13, v16 row_newbcast:7 row_mask:0xf bank_mask:0xf
    v_and_b32_dpp v25, v13, v17 row_newbcast:7 row_mask:0xf bank_mask:0xf
    s_waitcnt vmcnt(9)
    v_mfma_f32_16x16x32_bf16 v[26:29], v[104:107], v[18:21], v[26:29]
    v_and_b32_dpp v18, v13, v14 row_newbcast:8 row_mask:0xf bank_mask:0xf
    v_and_b32_dpp v19, v13, v15 row_newbcast:8 row_mask:0xf bank_mask:0xf
    v_and_b32_dpp v20, v13, v16 row_newbcast:8 row_mask:0xf bank_mask:0xf
    v_and_b32_dpp v21, v13, v17 row_newbcast:8 row_mask:0xf bank_mask:0xf
    s_waitcnt vmcnt(8)
    v_mfma_f32_16x16x32_bf16 v[26:29], v[108:111], v[22:25], v[26:29]
    v_and_b32_dpp v22, v13, v14 row_newbcast:9 row_mask:0xf bank_mask:0xf
    v_and_b32_dpp v23, v13, v15 row_newbcast:9 row_mask:0xf bank_mask:0xf
    v_and_b32_dpp v24, v13, v16 row_newbcast:9 row_mask:0xf bank_mask:0xf
    v_and_b32_dpp v25, v13, v17 row_newbcast:9 row_mask:0xf bank_mask:0xf
    s_waitcnt vmcnt(7)
    v_mfma_f32_16x16x32_bf16 v[26:29], v[112:115], v[18:21], v[26:29]
    v_and_b32_dpp v18, v13, v14 row_newbcast:10 row_mask:0xf bank_mask:0xf
    v_and_b32_dpp v19, v13, v15 row_newbcast:10 row_mask:0xf bank_mask:0xf
    v_and_b32_dpp v20, v13, v16 row_newbcast:10 row_mask:0xf bank_mask:0xf
    v_and_b32_dpp v21, v13, v17 row_newbcast:10 row_mask:0xf bank_mask:0xf
    s_waitcnt vmcnt(6)
    v_mfma_f32_16x16x32_bf16 v[26:29], v[116:119], v[22:25], v[26:29]
    v_and_b32_dpp v22, v13, v14 row_newbcast:11 row_mask:0xf bank_mask:0xf
    v_and_b32_dpp v23, v13, v15 row_newbcast:11 row_mask:0xf bank_mask:0xf
    v_and_b32_dpp v24, v13, v16 row_newbcast:11 row_mask:0xf bank_mask:0xf
    v_and_b32_dpp v25, v13, v17 row_newbcast:11 row_mask:0xf bank_mask:0xf
    s_waitcnt vmcnt(5)
    v_mfma_f32_16x16x32_bf16 v[26:29], v[120:123], v[18:21], v[26:29]
    v_and_b32_dpp v18, v13, v14 row_newbcast:12 row_mask:0xf bank_mask:0xf
    v_and_b32_dpp v19, v13, v15 row_newbcast:12 row_mask:0xf bank_mask:0xf
    v_and_b32_dpp v20, v13, v16 row_newbcast:12 row_mask:0xf bank_mask:0xf
    v_and_b32_dpp v21, v13, v17 row_newbcast:12 row_mask:0xf bank_mask:0xf
    s_waitcnt vmcnt(4)
    v_mfma_f32_16x16x32_bf16 v[26:29], v[124:127], v[22:25], v[26:29]
    v_and_b32_dpp v22, v13, v14 row_newbcast:13 row_mask:0xf bank_mask:0xf
    v_and_b32_dpp v23, v13, v15 row_newbcast:13 row_mask:0xf bank_mask:0xf
    v_and_b32_dpp v24, v13, v16 row_newbcast:13 row_mask:0xf bank_mask:0xf
    v_and_b32_dpp v25, v13, v17 row_newbcast:13 row_mask:0xf bank_mask:0xf
    s_waitcnt vmcnt(3)
    v_mfma_f32_16x16x32_bf16 v[26:29], v[128:131], v[18:21], v[26:29]
    v_and_b32_dpp v18, v13, v14 row_newbcast:14 row_mask:0xf bank_mask:0xf
    v_and_b32_dpp v19, v13, v15 row_newbcast:14 row_mask:0xf bank_mask:0xf
    v_and_b32_dpp v20, v13, v16 row_newbcast:14 row_mask:0xf bank_mask:0xf
    v_and_b32_dpp v21, v13, v17 row_newbcast:14 row_mask:0xf bank_mask:0xf
    s_waitcnt vmcnt(2)
    v_mfma_f32_16x16x32_bf16 v[26:29], v[132:135], v[22:25], v[26:29]
    v_and_b32_dpp v22, v13, v14 row_newbcast:15 row_mask:0xf bank_mask:0xf
    v_and_b32_dpp v23, v13, v15 row_newbcast:15 row_mask:0xf bank_mask:0xf
    v_and_b32_dpp v24, v13, v16 row_newbcast:15 row_mask:0xf bank_mask:0xf
    v_and_b32_dpp v25, v13, v17 row_newbcast:15 row_mask:0xf bank_mask:0xf
    s_waitcnt vmcnt(1)
    v_mfma_f32_16x16x32_bf16 v[26:29], v[136:139], v[18:21], v[26:29]
    s_waitcnt vmcnt(0)
    v_mfma_f32_16x16x32_bf16 v[26:29], v[140:143], v[22:25], v[26:29]
    s_mov_b64 exec, s[66:67]
    s_nop 6
    ds_write_b128 v30, v[26:29] offset:512
    s_waitcnt lgkmcnt(0)
    s_barrier
L_end:
    s_endpgm
    .section .rodata,"a"
    .p2align 6
    .amdhsa_kernel parallel_sum__mha_block_cached__dense_activation_silu__decode_kernel
      .amdhsa_next_free_vgpr 256
      .amdhsa_next_free_sgpr 102
      .amdhsa_accum_offset 256
      .amdhsa_group_segment_fixed_size 0
      .amdhsa_kernarg_size 88
      .amdhsa_user_sgpr_count 2
      .amdhsa_user_sgpr_kernarg_segment_ptr 1
      .amdhsa_system_sgpr_workgroup_id_x 1
    .end_amdhsa_kernel
```
